```python
import torch

def _softmax(x, axis=-1):
    return torch.softmax(x, dim=axis)
def _gelu(x):
    return torch.nn.functional.gelu(x, approximate="tanh")
def _silu(x):
    return torch.nn.functional.silu(x)
def _sigmoid(x):
    return torch.sigmoid(x)
def _layernorm(x, axis=-1, eps=1e-5):
    m = x.mean(dim=axis, keepdim=True)
    v = x.var(dim=axis, keepdim=True, unbiased=False)
    return (x - m) / torch.sqrt(v + eps)
def _scatter_add(tgt, idx, src, axis=0):
    return tgt.clone().index_add_(axis, idx, src)
def _segment_sum(src, seg, n):
    out = torch.zeros((n,) + src.shape[1:], dtype=src.dtype)
    return out.index_add_(0, seg, src)
def _pad(x, pw):
    flat = tuple(v for pair in reversed(pw) for v in pair)
    return torch.nn.functional.pad(x, flat)

kernel_name = 'parallel_sum__mha_block__glu_gated_swiglu__prompt'

def setup_inputs():

    _w = (lambda a: (lambda t: t.to(torch.bfloat16) if t.is_floating_point() else t)(torch.as_tensor(a)))
    def _A_setup():
        B, S, D, H = 1, 2048, 512, 32
        return {
            "x": _w((lambda *s: torch.randn(*s, dtype=torch.bfloat16) * 0.05)(B, S, D)),
            "wqkv": _w((lambda *s: torch.randn(*s, dtype=torch.bfloat16) * 0.05)(D, 3 * D)),
            "wo": _w((lambda *s: torch.randn(*s, dtype=torch.bfloat16) * 0.05)(D, D)),
        }
    _A_in = _A_setup()

    def _B_setup():
        B, S, D, F = 1, 2048, 512, 1376
        return {
            "x": _w((lambda *s: torch.randn(*s, dtype=torch.bfloat16) * 0.05)(B, S, D)),
            "w1": _w((lambda *s: torch.randn(*s, dtype=torch.bfloat16) * 0.4)(D, F) * (2.0 / D) ** 0.5),
            "w3": _w((lambda *s: torch.randn(*s, dtype=torch.bfloat16) * 0.4)(D, F) * (2.0 / D) ** 0.5),
            "w2": _w((lambda *s: torch.randn(*s, dtype=torch.bfloat16) * 0.4)(F, D) * (2.0 / F) ** 0.5),
        }
    _B_in = _B_setup()

    return {
        "A_x": _A_in["x"],
        "A_wqkv": _A_in["wqkv"],
        "A_wo": _A_in["wo"],
        "B_x": _B_in["x"],
        "B_w1": _B_in["w1"],
        "B_w3": _B_in["w3"],
        "B_w2": _B_in["w2"],
    }

def reference(A_x, A_wqkv, A_wo, B_x, B_w1, B_w3, B_w2):
    def _A_ref(x, wqkv, wo):
        B, S, D = x.shape
        H = 32
        Dh = D // H
        qkv = (lambda x, *d: x.permute(*d))((x @ wqkv).reshape(B, S, 3, H, Dh), 2, 0, 3, 1, 4)
        q, k, v = qkv[0], qkv[1], qkv[2]
        scores = torch.einsum("bhqd,bhkd->bhqk", q, k) * (Dh ** -0.5)
        p = _softmax(scores, axis=-1)
        o = torch.einsum("bhqk,bhkd->bhqd", p, v)
        return (lambda x, *d: x.permute(*d))(o, 0, 2, 1, 3).reshape(B, S, D) @ wo

    def _B_ref(x, w1, w3, w2):
        gate = torch.einsum("bsd,df->bsf", x, w1)
        up = torch.einsum("bsd,df->bsf", x, w3)
        h = _silu(gate) * up
        out = torch.einsum("bsf,fd->bsd", h, w2)
        return out

    x = A_x
    xn = _layernorm(x, axis=-1)
    return x + _A_ref(xn, A_wqkv, A_wo) + _B_ref(xn, B_w1, B_w3, B_w2)
```

```asm
; @launch grid=(256,1,1) block=(512,1,1) lds=163840
.amdgcn_target "amdgcn-amd-amdhsa--gfx950"
.text
.globl parallel_sum__mha_block__glu_gated_swiglu__prompt_kernel
.p2align 8
.type parallel_sum__mha_block__glu_gated_swiglu__prompt_kernel,@function
parallel_sum__mha_block__glu_gated_swiglu__prompt_kernel:
  s_cmp_ge_u32 s2, 256
  s_cbranch_scc1 parallel_sum__mha_block__glu_gated_swiglu__prompt_kernel_exit
  s_load_dwordx4 s[4:7], s[0:1], 0
  s_load_dwordx2 s[62:63], s[0:1], 72
  s_load_dwordx2 s[26:27], s[0:1], 32
  s_load_dwordx2 s[28:29], s[0:1], 40
  s_load_dwordx2 s[30:31], s[0:1], 48
  s_load_dwordx2 s[32:33], s[0:1], 16
  s_load_dwordx2 s[72:73], s[0:1], 56
  s_and_b32 s3, s2, 7
  s_lshr_b32 s52, s2, 3
  s_and_b32 s53, s3, 1
  s_lshl_b32 s53, s53, 3
  s_and_b32 s54, s52, 7
  s_add_u32 s37, s53, s54
  v_lshrrev_b32 v1, 6, v0
  v_and_b32 v16, 63, v0
  v_readfirstlane_b32 s34, v1
  v_lshrrev_b32 v17, 3, v16
  v_and_b32 v18, 7, v16
  v_lshlrev_b32 v21, 4, v18
  s_lshl_b32 s55, s34, 3
  v_add_u32 v19, s55, v17
  v_lshlrev_b32 v20, 10, v19
  v_add_u32 v20, v20, v21
  s_lshl_b32 s54, s37, 17
  s_add_u32 s55, s54, 65536
  s_waitcnt lgkmcnt(0)
  s_mov_b32 s8, s4
  s_mov_b32 s9, s5
  s_mov_b32 s10, 2097152
  s_mov_b32 s11, 0x20000
  s_mov_b32 s70, s4
  s_mov_b32 s71, s5
  buffer_load_dwordx4 v[128:131], v20, s[8:11], s54 offen offset:0
  buffer_load_dwordx4 v[144:147], v20, s[8:11], s54 offen offset:128
  buffer_load_dwordx4 v[160:163], v20, s[8:11], s54 offen offset:256
  buffer_load_dwordx4 v[176:179], v20, s[8:11], s54 offen offset:384
  buffer_load_dwordx4 v[192:195], v20, s[8:11], s54 offen offset:512
  buffer_load_dwordx4 v[208:211], v20, s[8:11], s54 offen offset:640
  buffer_load_dwordx4 v[224:227], v20, s[8:11], s54 offen offset:768
  buffer_load_dwordx4 v[240:243], v20, s[8:11], s54 offen offset:896
  buffer_load_dwordx4 v[132:135], v20, s[8:11], s55 offen offset:0
  buffer_load_dwordx4 v[148:151], v20, s[8:11], s55 offen offset:128
  buffer_load_dwordx4 v[164:167], v20, s[8:11], s55 offen offset:256
  buffer_load_dwordx4 v[180:183], v20, s[8:11], s55 offen offset:384
  buffer_load_dwordx4 v[196:199], v20, s[8:11], s55 offen offset:512
  buffer_load_dwordx4 v[212:215], v20, s[8:11], s55 offen offset:640
  buffer_load_dwordx4 v[228:231], v20, s[8:11], s55 offen offset:768
  buffer_load_dwordx4 v[244:247], v20, s[8:11], s55 offen offset:896
  s_lshr_b32 s53, s3, 1
  s_lshl_b32 s53, s53, 2
  s_lshr_b32 s54, s52, 3
  s_add_u32 s53, s53, s54
  s_lshl_b32 s53, s53, 2
  s_mov_b32 s54, 0xd821c760
  s_mov_b32 s55, 0xfba5e943
  s_lshr_b64 s[54:55], s[54:55], s53
  s_and_b32 s38, s54, 15
  v_lshlrev_b32 v2, 4, v16
  s_and_b32 s35, s34, 3
  s_lshr_b32 s36, s34, 2
  s_lshl_b32 s42, s37, 2
  s_add_u32 s42, s42, s35
  s_mov_b32 s24, s6
  s_mov_b32 s25, s7
  s_mov_b32 s20, s62
  s_mov_b32 s21, s63
  s_mov_b32 s22, 25165824
  s_mov_b32 s23, 0x20000
  s_add_u32 s78, s62, 24653824
  s_addc_u32 s79, s63, 0
  s_load_dword s74, s[78:79], 0
  s_cmp_lt_u32 s38, 12
  s_cbranch_scc0 parallel_sum__mha_block__glu_gated_swiglu__prompt_kernel_i0g_1
  s_mov_b32 s12, s24
  s_mov_b32 s13, s25
  s_mov_b32 s14, 1572864
  s_mov_b32 s15, 0x20000
  s_mov_b32 s16, s24
  s_mov_b32 s17, s25
  s_mov_b32 s18, 1572864
  s_mov_b32 s19, 0x20000
  s_lshl_b32 s39, s38, 8
  s_add_u32 s40, s39, 128
  s_mov_b32 s41, 196608
  s_lshl_b32 s58, s38, 7
  v_lshrrev_b32 v22, 3, v16
  s_lshl_b32 s52, s34, 3
  v_add_u32 v22, s52, v22
  s_mov_b32 s52, 3072
  v_mul_lo_u32 v22, v22, s52
  v_lshrrev_b32 v23, 4, v16
  v_and_b32 v23, 1, v23
  v_lshlrev_b32 v23, 5, v23
  v_and_b32 v24, 7, v16
  v_lshlrev_b32 v24, 4, v24
  v_xor_b32 v24, v23, v24
  v_add_u32 v3, v22, v24
  v_xor_b32 v24, 64, v24
  v_add_u32 v4, v22, v24
  s_branch parallel_sum__mha_block__glu_gated_swiglu__prompt_kernel_i0d_2
parallel_sum__mha_block__glu_gated_swiglu__prompt_kernel_i0g_1:
  s_mov_b32 s12, s26
  s_mov_b32 s13, s27
  s_mov_b32 s14, 1409024
  s_mov_b32 s15, 0x20000
  s_mov_b32 s16, s28
  s_mov_b32 s17, s29
  s_mov_b32 s18, 1409024
  s_mov_b32 s19, 0x20000
  s_lshl_b32 s53, s38, 1
  s_sub_u32 s53, s53, 12
  s_lshl_b32 s39, s53, 7
  s_mov_b32 s40, s39
  s_add_u32 s58, s39, 128
  s_mov_b32 s41, 176128
  v_lshrrev_b32 v22, 3, v16
  s_lshl_b32 s52, s34, 3
  v_add_u32 v22, s52, v22
  s_mov_b32 s52, 2752
  v_mul_lo_u32 v22, v22, s52
  v_lshrrev_b32 v23, 4, v16
  v_and_b32 v23, 1, v23
  v_lshlrev_b32 v23, 5, v23
  v_and_b32 v24, 7, v16
  v_lshlrev_b32 v24, 4, v24
  v_xor_b32 v24, v23, v24
  v_add_u32 v3, v22, v24
  v_xor_b32 v24, 64, v24
  v_add_u32 v4, v22, v24
parallel_sum__mha_block__glu_gated_swiglu__prompt_kernel_i0d_2:
  s_lshl_b32 s52, s34, 10
  s_add_u32 m0, s52, 131072
  s_add_u32 s53, s52, 139264
  buffer_load_dwordx4 v3, s[12:15], s39 offen lds
  s_mov_b32 m0, s53
  s_add_u32 s39, s39, s41
  buffer_load_dwordx4 v4, s[16:19], s40 offen lds
  s_add_u32 s40, s40, s41
  s_lshl_b32 s52, s34, 10
  s_add_u32 m0, s52, 147456
  s_add_u32 s53, s52, 155648
  buffer_load_dwordx4 v3, s[12:15], s39 offen lds
  s_mov_b32 m0, s53
  s_add_u32 s39, s39, s41
  buffer_load_dwordx4 v4, s[16:19], s40 offen lds
  s_add_u32 s40, s40, s41
  s_sub_u32 s53, s2, 236
  s_cmp_lt_u32 s2, 236
  s_cselect_b32 s52, s2, s53
  s_lshr_b32 s53, s52, 1
  s_and_b32 s52, s52, 1
  s_lshl_b32 s52, s52, 3
  s_add_u32 s52, s52, s34
  s_sub_u32 s54, s53, 86
  s_mov_b32 s55, 524288
  s_cmp_lt_u32 s53, 86
  s_cselect_b32 s48, s30, s32
  s_cselect_b32 s49, s31, s33
  s_cselect_b32 s50, 1409024, s55
  s_mov_b32 s51, 0x20000
  s_cselect_b32 s54, s53, s54
  s_mov_b32 s53, 32768
  s_cselect_b32 s53, 88064, s53
  s_mov_b32 s55, 16777216
  s_cselect_b32 s55, 14680064, s55
  s_mul_i32 s53, s53, s52
  s_add_u32 s55, s55, s53
  s_lshl_b32 s53, s54, 10
  s_add_u32 s47, s55, s53
  s_lshl_b32 s46, s54, 14
  s_lshl_b32 s52, s52, 6
  s_add_u32 s46, s46, s52
  v_lshrrev_b32 v22, 2, v16
  v_lshlrev_b32 v22, 10, v22
  v_and_b32 v23, 3, v16
  v_lshlrev_b32 v23, 4, v23
  v_add_u32 v22, v22, v23
  s_lshl_b32 s52, s34, 10
  s_add_u32 m0, s52, 114688
  s_nop 0
  buffer_load_dwordx4 v22, s[48:51], s46 offen lds
  s_sub_u32 s52, s2, 128
  s_cmp_lt_u32 s52, 24
  s_cbranch_scc0 parallel_sum__mha_block__glu_gated_swiglu__prompt_kernel_j2_3
  s_lshr_b32 s53, s52, 2
  s_and_b32 s52, s52, 3
  s_lshl_b32 s52, s52, 3
  s_add_u32 s52, s52, s34
  s_lshl_b32 s54, s53, 15
  s_lshl_b32 s55, s52, 10
  s_add_u32 s61, s54, s55
  s_add_u32 s61, s61, 18087936
  s_mul_i32 s52, s52, 44032
  s_add_u32 s53, s53, 80
  s_lshl_b32 s53, s53, 5
  s_add_u32 s54, s52, s53
  v_lshrrev_b32 v22, 2, v16
  v_mul_u32_u24 v22, 2752, v22
  v_and_b32 v23, 1, v16
  v_lshlrev_b32 v23, 4, v23
  v_add_u32 v22, v22, v23
  s_lshl_b32 s52, s34, 10
  s_add_u32 m0, s52, 122880
  s_mov_b32 s48, s26
  s_mov_b32 s49, s27
  s_mov_b32 s50, 1409024
  s_mov_b32 s51, 0x20000
  s_mov_b32 exec_lo, 0x33333333
  s_mov_b32 exec_hi, 0x33333333
  buffer_load_dwordx4 v22, s[48:51], s54 offen lds
  s_mov_b32 s48, s28
  s_mov_b32 s49, s29
  s_mov_b32 s50, 1409024
  s_mov_b32 s51, 0x20000
  s_mov_b32 exec_lo, 0xcccccccc
  s_mov_b32 exec_hi, 0xcccccccc
  buffer_load_dwordx4 v22, s[48:51], s54 offen lds
  s_mov_b64 exec, -1
parallel_sum__mha_block__glu_gated_swiglu__prompt_kernel_j2_3:
  v_lshrrev_b32 v22, 3, v16
  s_lshl_b32 s52, s34, 3
  v_add_u32 v22, s52, v22
  s_mov_b32 s52, 2752
  v_mul_lo_u32 v22, v22, s52
  v_lshrrev_b32 v23, 4, v16
  v_and_b32 v23, 1, v23
  v_lshlrev_b32 v23, 5, v23
  v_and_b32 v24, 7, v16
  v_lshlrev_b32 v24, 4, v24
  v_xor_b32 v24, v23, v24
  v_add_u32 v45, v22, v24
  v_xor_b32 v24, 64, v24
  v_add_u32 v47, v22, v24
  s_cmp_lt_u32 s38, 6
  s_cselect_b32 s59, s34, 255
  s_mul_i32 s53, s42, 88064
  s_add_u32 s45, s53, 6291456
  s_lshl_b32 s54, s36, 11
  s_add_u32 s53, s45, s54
  s_lshl_b32 s54, s58, 5
  s_add_u32 s44, s53, s54
  s_add_u32 s54, s38, 80
  s_lshl_b32 s54, s54, 10
  s_add_u32 s45, s45, s54
  s_sub_u32 s43, s44, 4096
  s_and_b32 s53, s38, 3
  s_lshl_b32 s53, s53, 3
  s_lshl_b32 s54, s36, 1
  s_add_u32 s53, s53, s54
  s_lshl_b32 s54, s53, 8
  s_lshl_b32 s55, s42, 2
  s_add_u32 s60, s54, s55
  s_lshl_b32 s53, s53, 16
  s_lshr_b32 s54, s38, 2
  s_lshl_b32 s54, s54, 21
  s_add_u32 s53, s53, s54
  s_lshl_b32 s54, s42, 10
  s_add_u32 s53, s53, s54
  s_cmp_lt_u32 s38, 12
  s_cselect_b32 s43, s53, s43
  v_lshrrev_b32 v22, 1, v19
  v_and_b32 v22, 7, v22
  v_xor_b32 v22, v22, v18
  v_lshlrev_b32 v22, 4, v22
  v_lshlrev_b32 v32, 7, v19
  v_add_u32 v32, v32, v22
  v_and_b32 v23, 31, v16
  s_lshl_b32 s52, s35, 5
  v_add_u32 v23, s52, v23
  v_lshlrev_b32 v23, 7, v23
  v_lshrrev_b32 v22, 1, v16
  v_and_b32 v22, 7, v22
  v_lshrrev_b32 v24, 5, v16
  v_xor_b32 v22, v22, v24
  v_lshlrev_b32 v22, 4, v22
  v_add_u32 v33, v23, v22
  v_xor_b32 v34, 32, v33
  v_xor_b32 v35, 64, v33
  v_xor_b32 v44, 96, v33
  v_lshrrev_b32 v22, 4, v16
  v_and_b32 v23, 1, v22
  v_lshrrev_b32 v22, 1, v22
  v_and_b32 v24, 15, v16
  v_lshrrev_b32 v28, 2, v24
  v_and_b32 v24, 3, v24
  v_lshlrev_b32 v29, 3, v22
  v_add_u32 v29, v29, v28
  v_lshlrev_b32 v29, 7, v29
  v_lshlrev_b32 v30, 13, v23
  v_add_u32 v29, v29, v30
  v_lshrrev_b32 v30, 1, v28
  v_lshlrev_b32 v31, 1, v23
  v_or_b32 v30, v30, v31
  s_lshl_b32 s52, s36, 1
  v_xor_b32 v30, s52, v30
  v_lshlrev_b32 v30, 5, v30
  v_lshlrev_b32 v31, 3, v24
  v_add_u32 v30, v30, v31
  v_add_u32 v29, v29, v30
  v_mov_b32 v5, v29
  v_xor_b32 v6, 32, v5
  v_add_u32 v7, 65536, v5
  v_add_u32 v8, 65536, v6
  v_lshlrev_b32 v29, 2, v22
  v_add_u32 v29, v29, v28
  v_lshlrev_b32 v29, 6, v29
  v_lshlrev_b32 v30, 5, v23
  v_add_u32 v29, v29, v30
  v_lshlrev_b32 v30, 3, v24
  v_add_u32 v29, v29, v30
  s_lshl_b32 s52, s34, 10
  s_add_u32 s52, s52, 114688
  v_add_u32 v46, s52, v29
  v_lshlrev_b32 v30, 18, v23
  v_lshlrev_b32 v31, 8, v22
  v_add_u32 v30, v30, v31
  v_and_b32 v31, 15, v16
  v_lshlrev_b32 v31, 4, v31
  v_add_u32 v15, v30, v31
  v_lshlrev_b32 v1, 10, v22
  s_mov_b32 s56, 0x3f803f80
  s_mov_b32 s57, 0xffff0000
  s_waitcnt vmcnt(13)
  v_mov_b32 v16, 0
  v_mov_b32 v17, 0
  v_mov_b32 v18, 0
  v_mov_b32 v19, 0
  v_dot2_f32_bf16 v16, v128, s56, v16
  v_dot2_f32_bf16 v18, v128, v128, v18
  v_dot2_f32_bf16 v17, v129, s56, v17
  v_dot2_f32_bf16 v19, v129, v129, v19
  v_dot2_f32_bf16 v16, v130, s56, v16
  v_dot2_f32_bf16 v18, v130, v130, v18
  v_dot2_f32_bf16 v17, v131, s56, v17
  v_dot2_f32_bf16 v19, v131, v131, v19
  v_dot2_f32_bf16 v16, v144, s56, v16
  v_dot2_f32_bf16 v18, v144, v144, v18
  v_dot2_f32_bf16 v17, v145, s56, v17
  v_dot2_f32_bf16 v19, v145, v145, v19
  v_dot2_f32_bf16 v16, v146, s56, v16
  v_dot2_f32_bf16 v18, v146, v146, v18
  v_dot2_f32_bf16 v17, v147, s56, v17
  v_dot2_f32_bf16 v19, v147, v147, v19
  v_dot2_f32_bf16 v16, v160, s56, v16
  v_dot2_f32_bf16 v18, v160, v160, v18
  v_dot2_f32_bf16 v17, v161, s56, v17
  v_dot2_f32_bf16 v19, v161, v161, v19
  v_dot2_f32_bf16 v16, v162, s56, v16
  v_dot2_f32_bf16 v18, v162, v162, v18
  v_dot2_f32_bf16 v17, v163, s56, v17
  v_dot2_f32_bf16 v19, v163, v163, v19
  v_dot2_f32_bf16 v16, v176, s56, v16
  v_dot2_f32_bf16 v18, v176, v176, v18
  v_dot2_f32_bf16 v17, v177, s56, v17
  v_dot2_f32_bf16 v19, v177, v177, v19
  v_dot2_f32_bf16 v16, v178, s56, v16
  v_dot2_f32_bf16 v18, v178, v178, v18
  v_dot2_f32_bf16 v17, v179, s56, v17
  v_dot2_f32_bf16 v19, v179, v179, v19
  v_dot2_f32_bf16 v16, v192, s56, v16
  v_dot2_f32_bf16 v18, v192, v192, v18
  v_dot2_f32_bf16 v17, v193, s56, v17
  v_dot2_f32_bf16 v19, v193, v193, v19
  v_dot2_f32_bf16 v16, v194, s56, v16
  v_dot2_f32_bf16 v18, v194, v194, v18
  v_dot2_f32_bf16 v17, v195, s56, v17
  v_dot2_f32_bf16 v19, v195, v195, v19
  v_dot2_f32_bf16 v16, v208, s56, v16
  v_dot2_f32_bf16 v18, v208, v208, v18
  v_dot2_f32_bf16 v17, v209, s56, v17
  v_dot2_f32_bf16 v19, v209, v209, v19
  v_dot2_f32_bf16 v16, v210, s56, v16
  v_dot2_f32_bf16 v18, v210, v210, v18
  v_dot2_f32_bf16 v17, v211, s56, v17
  v_dot2_f32_bf16 v19, v211, v211, v19
  v_dot2_f32_bf16 v16, v224, s56, v16
  v_dot2_f32_bf16 v18, v224, v224, v18
  v_dot2_f32_bf16 v17, v225, s56, v17
  v_dot2_f32_bf16 v19, v225, v225, v19
  v_dot2_f32_bf16 v16, v226, s56, v16
  v_dot2_f32_bf16 v18, v226, v226, v18
  v_dot2_f32_bf16 v17, v227, s56, v17
  v_dot2_f32_bf16 v19, v227, v227, v19
  v_dot2_f32_bf16 v16, v240, s56, v16
  v_dot2_f32_bf16 v18, v240, v240, v18
  v_dot2_f32_bf16 v17, v241, s56, v17
  v_dot2_f32_bf16 v19, v241, v241, v19
  v_dot2_f32_bf16 v16, v242, s56, v16
  v_dot2_f32_bf16 v18, v242, v242, v18
  v_dot2_f32_bf16 v17, v243, s56, v17
  v_dot2_f32_bf16 v19, v243, v243, v19
  s_waitcnt vmcnt(5)
  v_mov_b32 v20, 0
  v_mov_b32 v21, 0
  v_mov_b32 v22, 0
  v_mov_b32 v23, 0
  v_dot2_f32_bf16 v20, v132, s56, v20
  v_dot2_f32_bf16 v22, v132, v132, v22
  v_dot2_f32_bf16 v21, v133, s56, v21
  v_dot2_f32_bf16 v23, v133, v133, v23
  v_dot2_f32_bf16 v20, v134, s56, v20
  v_dot2_f32_bf16 v22, v134, v134, v22
  v_dot2_f32_bf16 v21, v135, s56, v21
  v_dot2_f32_bf16 v23, v135, v135, v23
  v_dot2_f32_bf16 v20, v148, s56, v20
  v_dot2_f32_bf16 v22, v148, v148, v22
  v_dot2_f32_bf16 v21, v149, s56, v21
  v_dot2_f32_bf16 v23, v149, v149, v23
  v_dot2_f32_bf16 v20, v150, s56, v20
  v_dot2_f32_bf16 v22, v150, v150, v22
  v_dot2_f32_bf16 v21, v151, s56, v21
  v_dot2_f32_bf16 v23, v151, v151, v23
  v_dot2_f32_bf16 v20, v164, s56, v20
  v_dot2_f32_bf16 v22, v164, v164, v22
  v_dot2_f32_bf16 v21, v165, s56, v21
  v_dot2_f32_bf16 v23, v165, v165, v23
  v_dot2_f32_bf16 v20, v166, s56, v20
  v_dot2_f32_bf16 v22, v166, v166, v22
  v_dot2_f32_bf16 v21, v167, s56, v21
  v_dot2_f32_bf16 v23, v167, v167, v23
  v_dot2_f32_bf16 v20, v180, s56, v20
  v_dot2_f32_bf16 v22, v180, v180, v22
  v_dot2_f32_bf16 v21, v181, s56, v21
  v_dot2_f32_bf16 v23, v181, v181, v23
  v_dot2_f32_bf16 v20, v182, s56, v20
  v_dot2_f32_bf16 v22, v182, v182, v22
  v_dot2_f32_bf16 v21, v183, s56, v21
  v_dot2_f32_bf16 v23, v183, v183, v23
  v_dot2_f32_bf16 v20, v196, s56, v20
  v_dot2_f32_bf16 v22, v196, v196, v22
  v_dot2_f32_bf16 v21, v197, s56, v21
  v_dot2_f32_bf16 v23, v197, v197, v23
  v_dot2_f32_bf16 v20, v198, s56, v20
  v_dot2_f32_bf16 v22, v198, v198, v22
  v_dot2_f32_bf16 v21, v199, s56, v21
  v_dot2_f32_bf16 v23, v199, v199, v23
  v_dot2_f32_bf16 v20, v212, s56, v20
  v_dot2_f32_bf16 v22, v212, v212, v22
  v_dot2_f32_bf16 v21, v213, s56, v21
  v_dot2_f32_bf16 v23, v213, v213, v23
  v_dot2_f32_bf16 v20, v214, s56, v20
  v_dot2_f32_bf16 v22, v214, v214, v22
  v_dot2_f32_bf16 v21, v215, s56, v21
  v_dot2_f32_bf16 v23, v215, v215, v23
  v_dot2_f32_bf16 v20, v228, s56, v20
  v_dot2_f32_bf16 v22, v228, v228, v22
  v_dot2_f32_bf16 v21, v229, s56, v21
  v_dot2_f32_bf16 v23, v229, v229, v23
  v_dot2_f32_bf16 v20, v230, s56, v20
  v_dot2_f32_bf16 v22, v230, v230, v22
  v_dot2_f32_bf16 v21, v231, s56, v21
  v_dot2_f32_bf16 v23, v231, v231, v23
  v_dot2_f32_bf16 v20, v244, s56, v20
  v_dot2_f32_bf16 v22, v244, v244, v22
  v_dot2_f32_bf16 v21, v245, s56, v21
  v_dot2_f32_bf16 v23, v245, v245, v23
  v_dot2_f32_bf16 v20, v246, s56, v20
  v_dot2_f32_bf16 v22, v246, v246, v22
  v_dot2_f32_bf16 v21, v247, s56, v21
  v_dot2_f32_bf16 v23, v247, v247, v23
  s_nop 2
  v_add_f32 v16, v16, v17
  v_add_f32 v18, v18, v19
  v_add_f32 v20, v20, v21
  v_add_f32 v22, v22, v23
  v_add_f32_dpp v16, v16, v16 quad_perm:[1,0,3,2] row_mask:0xf bank_mask:0xf
  v_add_f32_dpp v18, v18, v18 quad_perm:[1,0,3,2] row_mask:0xf bank_mask:0xf
  v_add_f32_dpp v20, v20, v20 quad_perm:[1,0,3,2] row_mask:0xf bank_mask:0xf
  v_add_f32_dpp v22, v22, v22 quad_perm:[1,0,3,2] row_mask:0xf bank_mask:0xf
  v_add_f32_dpp v16, v16, v16 quad_perm:[2,3,0,1] row_mask:0xf bank_mask:0xf
  v_add_f32_dpp v18, v18, v18 quad_perm:[2,3,0,1] row_mask:0xf bank_mask:0xf
  v_add_f32_dpp v20, v20, v20 quad_perm:[2,3,0,1] row_mask:0xf bank_mask:0xf
  v_add_f32_dpp v22, v22, v22 quad_perm:[2,3,0,1] row_mask:0xf bank_mask:0xf
  v_add_f32_dpp v16, v16, v16 row_half_mirror row_mask:0xf bank_mask:0xf
  v_add_f32_dpp v18, v18, v18 row_half_mirror row_mask:0xf bank_mask:0xf
  v_add_f32_dpp v20, v20, v20 row_half_mirror row_mask:0xf bank_mask:0xf
  v_add_f32_dpp v22, v22, v22 row_half_mirror row_mask:0xf bank_mask:0xf
  v_mul_f32 v17, 0x3b000000, v16
  v_mul_f32 v18, 0x3b000000, v18
  v_mul_f32 v21, 0x3b000000, v20
  v_mul_f32 v22, 0x3b000000, v22
  v_fma_f32 v18, -v17, v17, v18
  v_fma_f32 v22, -v21, v21, v22
  v_max_f32 v18, 0, v18
  v_max_f32 v22, 0, v22
  v_add_f32 v18, 0x3727c5ac, v18
  v_add_f32 v22, 0x3727c5ac, v22
  v_rsq_f32 v24, v18
  v_rsq_f32 v28, v22
  s_nop 0
  v_mul_f32 v26, v17, v24
  v_mul_f32 v30, v21, v28
  v_sub_f32 v26, 0, v26
  v_sub_f32 v30, 0, v30
  v_lshlrev_b32 v16, 16, v128
  v_lshlrev_b32 v18, 16, v129
  v_lshlrev_b32 v20, 16, v130
  v_lshlrev_b32 v22, 16, v131
  v_and_b32 v17, s57, v128
  v_and_b32 v19, s57, v129
  v_and_b32 v21, s57, v130
  v_and_b32 v23, s57, v131
  v_pk_fma_f32 v[16:17], v[16:17], v[24:25], v[26:27] op_sel_hi:[1,0,0]
  v_pk_fma_f32 v[18:19], v[18:19], v[24:25], v[26:27] op_sel_hi:[1,0,0]
  v_pk_fma_f32 v[20:21], v[20:21], v[24:25], v[26:27] op_sel_hi:[1,0,0]
  v_pk_fma_f32 v[22:23], v[22:23], v[24:25], v[26:27] op_sel_hi:[1,0,0]
  v_cvt_pk_bf16_f32 v128, v16, v17
  v_cvt_pk_bf16_f32 v129, v18, v19
  v_cvt_pk_bf16_f32 v130, v20, v21
  v_cvt_pk_bf16_f32 v131, v22, v23
  ds_write_b128 v32, v[128:131] offset:0
  v_lshlrev_b32 v16, 16, v132
  v_lshlrev_b32 v18, 16, v133
  v_lshlrev_b32 v20, 16, v134
  v_lshlrev_b32 v22, 16, v135
  v_and_b32 v17, s57, v132
  v_and_b32 v19, s57, v133
  v_and_b32 v21, s57, v134
  v_and_b32 v23, s57, v135
  v_pk_fma_f32 v[16:17], v[16:17], v[28:29], v[30:31] op_sel_hi:[1,0,0]
  v_pk_fma_f32 v[18:19], v[18:19], v[28:29], v[30:31] op_sel_hi:[1,0,0]
  v_pk_fma_f32 v[20:21], v[20:21], v[28:29], v[30:31] op_sel_hi:[1,0,0]
  v_pk_fma_f32 v[22:23], v[22:23], v[28:29], v[30:31] op_sel_hi:[1,0,0]
  v_cvt_pk_bf16_f32 v132, v16, v17
  v_cvt_pk_bf16_f32 v133, v18, v19
  v_cvt_pk_bf16_f32 v134, v20, v21
  v_cvt_pk_bf16_f32 v135, v22, v23
  ds_write_b128 v32, v[132:135] offset:8192
  v_lshlrev_b32 v16, 16, v144
  v_lshlrev_b32 v18, 16, v145
  v_lshlrev_b32 v20, 16, v146
  v_lshlrev_b32 v22, 16, v147
  v_and_b32 v17, s57, v144
  v_and_b32 v19, s57, v145
  v_and_b32 v21, s57, v146
  v_and_b32 v23, s57, v147
  v_pk_fma_f32 v[16:17], v[16:17], v[24:25], v[26:27] op_sel_hi:[1,0,0]
  v_pk_fma_f32 v[18:19], v[18:19], v[24:25], v[26:27] op_sel_hi:[1,0,0]
  v_pk_fma_f32 v[20:21], v[20:21], v[24:25], v[26:27] op_sel_hi:[1,0,0]
  v_pk_fma_f32 v[22:23], v[22:23], v[24:25], v[26:27] op_sel_hi:[1,0,0]
  v_cvt_pk_bf16_f32 v144, v16, v17
  v_cvt_pk_bf16_f32 v145, v18, v19
  v_cvt_pk_bf16_f32 v146, v20, v21
  v_cvt_pk_bf16_f32 v147, v22, v23
  ds_write_b128 v32, v[144:147] offset:16384
  v_lshlrev_b32 v16, 16, v148
  v_lshlrev_b32 v18, 16, v149
  v_lshlrev_b32 v20, 16, v150
  v_lshlrev_b32 v22, 16, v151
  v_and_b32 v17, s57, v148
  v_and_b32 v19, s57, v149
  v_and_b32 v21, s57, v150
  v_and_b32 v23, s57, v151
  v_pk_fma_f32 v[16:17], v[16:17], v[28:29], v[30:31] op_sel_hi:[1,0,0]
  v_pk_fma_f32 v[18:19], v[18:19], v[28:29], v[30:31] op_sel_hi:[1,0,0]
  v_pk_fma_f32 v[20:21], v[20:21], v[28:29], v[30:31] op_sel_hi:[1,0,0]
  v_pk_fma_f32 v[22:23], v[22:23], v[28:29], v[30:31] op_sel_hi:[1,0,0]
  v_cvt_pk_bf16_f32 v148, v16, v17
  v_cvt_pk_bf16_f32 v149, v18, v19
  v_cvt_pk_bf16_f32 v150, v20, v21
  v_cvt_pk_bf16_f32 v151, v22, v23
  ds_write_b128 v32, v[148:151] offset:24576
  v_lshlrev_b32 v16, 16, v160
  v_lshlrev_b32 v18, 16, v161
  v_lshlrev_b32 v20, 16, v162
  v_lshlrev_b32 v22, 16, v163
  v_and_b32 v17, s57, v160
  v_and_b32 v19, s57, v161
  v_and_b32 v21, s57, v162
  v_and_b32 v23, s57, v163
  v_pk_fma_f32 v[16:17], v[16:17], v[24:25], v[26:27] op_sel_hi:[1,0,0]
  v_pk_fma_f32 v[18:19], v[18:19], v[24:25], v[26:27] op_sel_hi:[1,0,0]
  v_pk_fma_f32 v[20:21], v[20:21], v[24:25], v[26:27] op_sel_hi:[1,0,0]
  v_pk_fma_f32 v[22:23], v[22:23], v[24:25], v[26:27] op_sel_hi:[1,0,0]
  v_cvt_pk_bf16_f32 v160, v16, v17
  v_cvt_pk_bf16_f32 v161, v18, v19
  v_cvt_pk_bf16_f32 v162, v20, v21
  v_cvt_pk_bf16_f32 v163, v22, v23
  ds_write_b128 v32, v[160:163] offset:32768
  v_lshlrev_b32 v16, 16, v164
  v_lshlrev_b32 v18, 16, v165
  v_lshlrev_b32 v20, 16, v166
  v_lshlrev_b32 v22, 16, v167
  v_and_b32 v17, s57, v164
  v_and_b32 v19, s57, v165
  v_and_b32 v21, s57, v166
  v_and_b32 v23, s57, v167
  v_pk_fma_f32 v[16:17], v[16:17], v[28:29], v[30:31] op_sel_hi:[1,0,0]
  v_pk_fma_f32 v[18:19], v[18:19], v[28:29], v[30:31] op_sel_hi:[1,0,0]
  v_pk_fma_f32 v[20:21], v[20:21], v[28:29], v[30:31] op_sel_hi:[1,0,0]
  v_pk_fma_f32 v[22:23], v[22:23], v[28:29], v[30:31] op_sel_hi:[1,0,0]
  v_cvt_pk_bf16_f32 v164, v16, v17
  v_cvt_pk_bf16_f32 v165, v18, v19
  v_cvt_pk_bf16_f32 v166, v20, v21
  v_cvt_pk_bf16_f32 v167, v22, v23
  ds_write_b128 v32, v[164:167] offset:40960
  v_lshlrev_b32 v16, 16, v176
  v_lshlrev_b32 v18, 16, v177
  v_lshlrev_b32 v20, 16, v178
  v_lshlrev_b32 v22, 16, v179
  v_and_b32 v17, s57, v176
  v_and_b32 v19, s57, v177
  v_and_b32 v21, s57, v178
  v_and_b32 v23, s57, v179
  v_pk_fma_f32 v[16:17], v[16:17], v[24:25], v[26:27] op_sel_hi:[1,0,0]
  v_pk_fma_f32 v[18:19], v[18:19], v[24:25], v[26:27] op_sel_hi:[1,0,0]
  v_pk_fma_f32 v[20:21], v[20:21], v[24:25], v[26:27] op_sel_hi:[1,0,0]
  v_pk_fma_f32 v[22:23], v[22:23], v[24:25], v[26:27] op_sel_hi:[1,0,0]
  v_cvt_pk_bf16_f32 v176, v16, v17
  v_cvt_pk_bf16_f32 v177, v18, v19
  v_cvt_pk_bf16_f32 v178, v20, v21
  v_cvt_pk_bf16_f32 v179, v22, v23
  ds_write_b128 v32, v[176:179] offset:49152
  v_lshlrev_b32 v16, 16, v180
  v_lshlrev_b32 v18, 16, v181
  v_lshlrev_b32 v20, 16, v182
  v_lshlrev_b32 v22, 16, v183
  v_and_b32 v17, s57, v180
  v_and_b32 v19, s57, v181
  v_and_b32 v21, s57, v182
  v_and_b32 v23, s57, v183
  v_pk_fma_f32 v[16:17], v[16:17], v[28:29], v[30:31] op_sel_hi:[1,0,0]
  v_pk_fma_f32 v[18:19], v[18:19], v[28:29], v[30:31] op_sel_hi:[1,0,0]
  v_pk_fma_f32 v[20:21], v[20:21], v[28:29], v[30:31] op_sel_hi:[1,0,0]
  v_pk_fma_f32 v[22:23], v[22:23], v[28:29], v[30:31] op_sel_hi:[1,0,0]
  v_cvt_pk_bf16_f32 v180, v16, v17
  v_cvt_pk_bf16_f32 v181, v18, v19
  v_cvt_pk_bf16_f32 v182, v20, v21
  v_cvt_pk_bf16_f32 v183, v22, v23
  ds_write_b128 v32, v[180:183] offset:57344
  v_add_u32 v32, 65536, v32
  v_lshlrev_b32 v16, 16, v192
  v_lshlrev_b32 v18, 16, v193
  v_lshlrev_b32 v20, 16, v194
  v_lshlrev_b32 v22, 16, v195
  v_and_b32 v17, s57, v192
  v_and_b32 v19, s57, v193
  v_and_b32 v21, s57, v194
  v_and_b32 v23, s57, v195
  v_pk_fma_f32 v[16:17], v[16:17], v[24:25], v[26:27] op_sel_hi:[1,0,0]
  v_pk_fma_f32 v[18:19], v[18:19], v[24:25], v[26:27] op_sel_hi:[1,0,0]
  v_pk_fma_f32 v[20:21], v[20:21], v[24:25], v[26:27] op_sel_hi:[1,0,0]
  v_pk_fma_f32 v[22:23], v[22:23], v[24:25], v[26:27] op_sel_hi:[1,0,0]
  v_cvt_pk_bf16_f32 v192, v16, v17
  v_cvt_pk_bf16_f32 v193, v18, v19
  v_cvt_pk_bf16_f32 v194, v20, v21
  v_cvt_pk_bf16_f32 v195, v22, v23
  ds_write_b128 v32, v[192:195] offset:0
  v_lshlrev_b32 v16, 16, v196
  v_lshlrev_b32 v18, 16, v197
  v_lshlrev_b32 v20, 16, v198
  v_lshlrev_b32 v22, 16, v199
  v_and_b32 v17, s57, v196
  v_and_b32 v19, s57, v197
  v_and_b32 v21, s57, v198
  v_and_b32 v23, s57, v199
  v_pk_fma_f32 v[16:17], v[16:17], v[28:29], v[30:31] op_sel_hi:[1,0,0]
  v_pk_fma_f32 v[18:19], v[18:19], v[28:29], v[30:31] op_sel_hi:[1,0,0]
  v_pk_fma_f32 v[20:21], v[20:21], v[28:29], v[30:31] op_sel_hi:[1,0,0]
  v_pk_fma_f32 v[22:23], v[22:23], v[28:29], v[30:31] op_sel_hi:[1,0,0]
  v_cvt_pk_bf16_f32 v196, v16, v17
  v_cvt_pk_bf16_f32 v197, v18, v19
  v_cvt_pk_bf16_f32 v198, v20, v21
  v_cvt_pk_bf16_f32 v199, v22, v23
  ds_write_b128 v32, v[196:199] offset:8192
  s_waitcnt vmcnt(0)
  ds_read_b64_tr_b16 v[64:65], v46 offset:0
  ds_read_b64_tr_b16 v[66:67], v46 offset:512
  s_sub_u32 s52, s2, 128
  s_cmp_lt_u32 s52, 24
  s_cbranch_scc0 parallel_sum__mha_block__glu_gated_swiglu__prompt_kernel_j2r_4
  v_and_b32 v72, 63, v0
  v_lshrrev_b32 v73, 5, v72
  v_lshlrev_b32 v73, 3, v73
  v_and_b32 v74, 15, v72
  v_lshrrev_b32 v74, 2, v74
  v_add_u32 v73, v73, v74
  v_lshlrev_b32 v73, 6, v73
  v_lshrrev_b32 v74, 4, v72
  v_and_b32 v74, 1, v74
  v_lshlrev_b32 v74, 5, v74
  v_add_u32 v73, v73, v74
  v_and_b32 v74, 3, v72
  v_lshlrev_b32 v74, 3, v74
  v_add_u32 v73, v73, v74
  s_lshl_b32 s52, s34, 10
  s_add_u32 s52, s52, 122880
  v_add_u32 v73, s52, v73
  ds_read_b64_tr_b16 v[68:69], v73 offset:0
  ds_read_b64_tr_b16 v[70:71], v73 offset:256
parallel_sum__mha_block__glu_gated_swiglu__prompt_kernel_j2r_4:
  v_lshlrev_b32 v16, 16, v208
  v_lshlrev_b32 v18, 16, v209
  v_lshlrev_b32 v20, 16, v210
  v_lshlrev_b32 v22, 16, v211
  v_and_b32 v17, s57, v208
  v_and_b32 v19, s57, v209
  v_and_b32 v21, s57, v210
  v_and_b32 v23, s57, v211
  v_pk_fma_f32 v[16:17], v[16:17], v[24:25], v[26:27] op_sel_hi:[1,0,0]
  v_pk_fma_f32 v[18:19], v[18:19], v[24:25], v[26:27] op_sel_hi:[1,0,0]
  v_pk_fma_f32 v[20:21], v[20:21], v[24:25], v[26:27] op_sel_hi:[1,0,0]
  v_pk_fma_f32 v[22:23], v[22:23], v[24:25], v[26:27] op_sel_hi:[1,0,0]
  v_cvt_pk_bf16_f32 v208, v16, v17
  v_cvt_pk_bf16_f32 v209, v18, v19
  v_cvt_pk_bf16_f32 v210, v20, v21
  v_cvt_pk_bf16_f32 v211, v22, v23
  ds_write_b128 v32, v[208:211] offset:16384
  v_lshlrev_b32 v16, 16, v212
  v_lshlrev_b32 v18, 16, v213
  v_lshlrev_b32 v20, 16, v214
  v_lshlrev_b32 v22, 16, v215
  v_and_b32 v17, s57, v212
  v_and_b32 v19, s57, v213
  v_and_b32 v21, s57, v214
  v_and_b32 v23, s57, v215
  v_pk_fma_f32 v[16:17], v[16:17], v[28:29], v[30:31] op_sel_hi:[1,0,0]
  v_pk_fma_f32 v[18:19], v[18:19], v[28:29], v[30:31] op_sel_hi:[1,0,0]
  v_pk_fma_f32 v[20:21], v[20:21], v[28:29], v[30:31] op_sel_hi:[1,0,0]
  v_pk_fma_f32 v[22:23], v[22:23], v[28:29], v[30:31] op_sel_hi:[1,0,0]
  v_cvt_pk_bf16_f32 v212, v16, v17
  v_cvt_pk_bf16_f32 v213, v18, v19
  v_cvt_pk_bf16_f32 v214, v20, v21
  v_cvt_pk_bf16_f32 v215, v22, v23
  ds_write_b128 v32, v[212:215] offset:24576
  v_lshlrev_b32 v16, 16, v224
  v_lshlrev_b32 v18, 16, v225
  v_lshlrev_b32 v20, 16, v226
  v_lshlrev_b32 v22, 16, v227
  v_and_b32 v17, s57, v224
  v_and_b32 v19, s57, v225
  v_and_b32 v21, s57, v226
  v_and_b32 v23, s57, v227
  v_pk_fma_f32 v[16:17], v[16:17], v[24:25], v[26:27] op_sel_hi:[1,0,0]
  v_pk_fma_f32 v[18:19], v[18:19], v[24:25], v[26:27] op_sel_hi:[1,0,0]
  v_pk_fma_f32 v[20:21], v[20:21], v[24:25], v[26:27] op_sel_hi:[1,0,0]
  v_pk_fma_f32 v[22:23], v[22:23], v[24:25], v[26:27] op_sel_hi:[1,0,0]
  v_cvt_pk_bf16_f32 v224, v16, v17
  v_cvt_pk_bf16_f32 v225, v18, v19
  v_cvt_pk_bf16_f32 v226, v20, v21
  v_cvt_pk_bf16_f32 v227, v22, v23
  ds_write_b128 v32, v[224:227] offset:32768
  v_lshlrev_b32 v16, 16, v228
  v_lshlrev_b32 v18, 16, v229
  v_lshlrev_b32 v20, 16, v230
  v_lshlrev_b32 v22, 16, v231
  v_and_b32 v17, s57, v228
  v_and_b32 v19, s57, v229
  v_and_b32 v21, s57, v230
  v_and_b32 v23, s57, v231
  v_pk_fma_f32 v[16:17], v[16:17], v[28:29], v[30:31] op_sel_hi:[1,0,0]
  v_pk_fma_f32 v[18:19], v[18:19], v[28:29], v[30:31] op_sel_hi:[1,0,0]
  v_pk_fma_f32 v[20:21], v[20:21], v[28:29], v[30:31] op_sel_hi:[1,0,0]
  v_pk_fma_f32 v[22:23], v[22:23], v[28:29], v[30:31] op_sel_hi:[1,0,0]
  v_cvt_pk_bf16_f32 v228, v16, v17
  v_cvt_pk_bf16_f32 v229, v18, v19
  v_cvt_pk_bf16_f32 v230, v20, v21
  v_cvt_pk_bf16_f32 v231, v22, v23
  ds_write_b128 v32, v[228:231] offset:40960
  s_waitcnt lgkmcnt(0)
  s_mul_i32 s74, s74, 0x9e3779b1
  s_add_u32 s74, s74, 0x7f4a7c15
  buffer_store_dwordx4 v[64:67], v2, s[20:23], s47 offen sc1
  s_and_b32 s77, s2, 7
  s_lshr_b32 s78, s2, 3
  s_lshl_b32 s77, s77, 2
  s_and_b32 s79, s78, 3
  s_add_u32 s77, s77, s79
  s_lshr_b32 s78, s78, 2
  s_lshl_b32 s78, s78, 3
  s_add_u32 s78, s78, s34
  s_lshl_b32 s78, s78, 15
  s_lshl_b32 s77, s77, 10
  s_add_u32 s77, s77, s78
  s_add_u32 s77, s77, 12582912
  v_mov_b32 v72, -1
  v_mov_b32 v73, -1
  v_mov_b32 v74, -1
  v_mov_b32 v75, -1
  buffer_store_dwordx4 v[72:75], v2, s[20:23], s77 offen sc1
  s_sub_u32 s52, s2, 128
  s_cmp_lt_u32 s52, 24
  s_cbranch_scc0 parallel_sum__mha_block__glu_gated_swiglu__prompt_kernel_j2s_5
  buffer_store_dwordx4 v[68:71], v2, s[20:23], s61 offen sc1
parallel_sum__mha_block__glu_gated_swiglu__prompt_kernel_j2s_5:
  v_lshlrev_b32 v16, 16, v240
  v_lshlrev_b32 v18, 16, v241
  v_lshlrev_b32 v20, 16, v242
  v_lshlrev_b32 v22, 16, v243
  v_and_b32 v17, s57, v240
  v_and_b32 v19, s57, v241
  v_and_b32 v21, s57, v242
  v_and_b32 v23, s57, v243
  v_pk_fma_f32 v[16:17], v[16:17], v[24:25], v[26:27] op_sel_hi:[1,0,0]
  v_pk_fma_f32 v[18:19], v[18:19], v[24:25], v[26:27] op_sel_hi:[1,0,0]
  v_pk_fma_f32 v[20:21], v[20:21], v[24:25], v[26:27] op_sel_hi:[1,0,0]
  v_pk_fma_f32 v[22:23], v[22:23], v[24:25], v[26:27] op_sel_hi:[1,0,0]
  v_cvt_pk_bf16_f32 v240, v16, v17
  v_cvt_pk_bf16_f32 v241, v18, v19
  v_cvt_pk_bf16_f32 v242, v20, v21
  v_cvt_pk_bf16_f32 v243, v22, v23
  ds_write_b128 v32, v[240:243] offset:49152
  v_lshlrev_b32 v16, 16, v244
  v_lshlrev_b32 v18, 16, v245
  v_lshlrev_b32 v20, 16, v246
  v_lshlrev_b32 v22, 16, v247
  v_and_b32 v17, s57, v244
  v_and_b32 v19, s57, v245
  v_and_b32 v21, s57, v246
  v_and_b32 v23, s57, v247
  v_pk_fma_f32 v[16:17], v[16:17], v[28:29], v[30:31] op_sel_hi:[1,0,0]
  v_pk_fma_f32 v[18:19], v[18:19], v[28:29], v[30:31] op_sel_hi:[1,0,0]
  v_pk_fma_f32 v[20:21], v[20:21], v[28:29], v[30:31] op_sel_hi:[1,0,0]
  v_pk_fma_f32 v[22:23], v[22:23], v[28:29], v[30:31] op_sel_hi:[1,0,0]
  v_cvt_pk_bf16_f32 v244, v16, v17
  v_cvt_pk_bf16_f32 v245, v18, v19
  v_cvt_pk_bf16_f32 v246, v20, v21
  v_cvt_pk_bf16_f32 v247, v22, v23
  ds_write_b128 v32, v[244:247] offset:57344
  s_cmp_eq_u32 s36, 0
  s_cbranch_scc0 parallel_sum__mha_block__glu_gated_swiglu__prompt_kernel_wpf_6
  v_and_b32 v16, 63, v0
  s_and_b32 s52, s37, 7
  s_lshl_b32 s52, s52, 2
  s_and_b32 s53, s34, 3
  s_add_u32 s52, s52, s53
  s_lshl_b32 s52, s52, 4
  v_lshrrev_b32 v76, 3, v16
  v_add_u32 v76, s52, v76
  v_and_b32 v77, 7, v16
  s_lshl_b32 s53, s38, 8
  s_cmp_lt_u32 s38, 12
  s_cselect_b32 s53, s53, 0
  v_and_b32 v78, 1, v77
  v_lshlrev_b32 v78, 7, v78
  v_mul_u32_u24 v81, 3072, v76
  v_add_u32 v81, v81, v78
  v_and_b32 v78, 1, v77
  v_mul_u32_u24 v78, 124, v78
  s_mov_b32 s48, s24
  s_mov_b32 s49, s25
  s_mov_b32 s50, 1572864
  s_mov_b32 s51, 0x20000
  s_add_u32 s54, s53, 0
  buffer_load_dword v25, v81, s[48:51], s54 offen
  s_add_u32 s54, s53, 24576
  buffer_load_dword v25, v81, s[48:51], s54 offen
  s_sub_u32 s53, s58, 128
  s_cmp_lt_u32 s38, 12
  s_cselect_b32 s53, s58, s53
  s_add_u32 s54, s38, 80
  s_lshl_b32 s54, s54, 5
  s_cmp_lt_u32 s38, 0
  s_cselect_b32 s54, s54, s58
  v_mov_b32 v79, s58
  v_cmp_le_u32 vcc, 2, v77
  v_mov_b32 v80, s53
  s_nop 0
  v_cndmask_b32 v79, v79, v80, vcc
  v_add_u32 v79, v79, v78
  v_cmp_le_u32 vcc, 4, v77
  v_mov_b32 v80, s54
  s_nop 0
  v_cndmask_b32 v79, v79, v80, vcc
  v_mul_u32_u24 v78, 2752, v76
  v_add_u32 v79, v79, v78
  s_mov_b32 s48, s26
  s_mov_b32 s49, s27
  s_mov_b32 s50, 1409024
  s_mov_b32 s51, 0x20000
  s_mov_b32 s53, 0
  buffer_load_dword v27, v79, s[48:51], s53 offen
  s_mov_b32 s53, 22016
  buffer_load_dword v27, v79, s[48:51], s53 offen
  s_mov_b32 s48, s28
  s_mov_b32 s49, s29
  s_mov_b32 s50, 1409024
  s_mov_b32 s51, 0x20000
  s_mov_b32 s53, 0
  buffer_load_dword v27, v79, s[48:51], s53 offen
  s_mov_b32 s53, 22016
  buffer_load_dword v27, v79, s[48:51], s53 offen
parallel_sum__mha_block__glu_gated_swiglu__prompt_kernel_wpf_6:
  s_waitcnt lgkmcnt(0)
  s_barrier
  ds_read_b128 v[128:131], v33 offset:0
  ds_read_b128 v[132:135], v34 offset:0
  ds_read_b128 v[136:139], v35 offset:0
  ds_read_b128 v[140:143], v44 offset:0
  ds_read_b128 v[144:147], v33 offset:16384
  ds_read_b128 v[148:151], v34 offset:16384
  ds_read_b128 v[152:155], v35 offset:16384
  ds_read_b128 v[156:159], v44 offset:16384
  ds_read_b128 v[160:163], v33 offset:32768
  ds_read_b128 v[164:167], v34 offset:32768
  ds_read_b128 v[168:171], v35 offset:32768
  ds_read_b128 v[172:175], v44 offset:32768
  ds_read_b128 v[176:179], v33 offset:49152
  ds_read_b128 v[180:183], v34 offset:49152
  ds_read_b128 v[184:187], v35 offset:49152
  ds_read_b128 v[188:191], v44 offset:49152
  v_add_u32 v33, 65536, v33
  v_add_u32 v34, 65536, v34
  v_add_u32 v35, 65536, v35
  v_add_u32 v44, 65536, v44
  ds_read_b128 v[192:195], v33 offset:0
  ds_read_b128 v[196:199], v34 offset:0
  ds_read_b128 v[200:203], v35 offset:0
  ds_read_b128 v[204:207], v44 offset:0
  ds_read_b128 v[208:211], v33 offset:16384
  ds_read_b128 v[212:215], v34 offset:16384
  ds_read_b128 v[216:219], v35 offset:16384
  ds_read_b128 v[220:223], v44 offset:16384
  ds_read_b128 v[224:227], v33 offset:32768
  ds_read_b128 v[228:231], v34 offset:32768
  ds_read_b128 v[232:235], v35 offset:32768
  ds_read_b128 v[236:239], v44 offset:32768
  ds_read_b128 v[240:243], v33 offset:49152
  ds_read_b128 v[244:247], v34 offset:49152
  ds_read_b128 v[248:251], v35 offset:49152
  ds_read_b128 v[252:255], v44 offset:49152
  s_waitcnt lgkmcnt(0)
  v_add_u32 v33, 131072, v5
  v_add_u32 v34, 131072, v6
  s_barrier
  s_lshl_b32 s52, s34, 10
  s_add_u32 m0, s52, 0
  s_add_u32 s53, s52, 8192
  buffer_load_dwordx4 v3, s[12:15], s39 offen lds
  s_mov_b32 m0, s53
  s_add_u32 s39, s39, s41
  buffer_load_dwordx4 v4, s[16:19], s40 offen lds
  s_add_u32 s40, s40, s41
  s_lshl_b32 s52, s34, 10
  s_add_u32 m0, s52, 16384
  s_add_u32 s53, s52, 24576
  buffer_load_dwordx4 v3, s[12:15], s39 offen lds
  s_mov_b32 m0, s53
  s_add_u32 s39, s39, s41
  buffer_load_dwordx4 v4, s[16:19], s40 offen lds
  s_add_u32 s40, s40, s41
  s_lshl_b32 s52, s34, 10
  s_add_u32 m0, s52, 32768
  s_add_u32 s53, s52, 40960
  buffer_load_dwordx4 v3, s[12:15], s39 offen lds
  s_mov_b32 m0, s53
  s_add_u32 s39, s39, s41
  buffer_load_dwordx4 v4, s[16:19], s40 offen lds
  s_add_u32 s40, s40, s41
  ds_read_b64_tr_b16 v[48:49], v33 offset:0
  ds_read_b64_tr_b16 v[50:51], v33 offset:512
  ds_read_b64_tr_b16 v[52:53], v34 offset:0
  ds_read_b64_tr_b16 v[54:55], v34 offset:512
  ds_read_b64_tr_b16 v[56:57], v33 offset:2048
  ds_read_b64_tr_b16 v[58:59], v33 offset:2560
  ds_read_b64_tr_b16 v[60:61], v34 offset:2048
  ds_read_b64_tr_b16 v[62:63], v34 offset:2560
  s_sub_u32 s52, s38, 8
  s_cmp_lt_u32 s52, 4
  s_cbranch_scc1 parallel_sum__mha_block__glu_gated_swiglu__prompt_kernel_i0s
  s_waitcnt lgkmcnt(6)
  v_mfma_f32_32x32x16_bf16 v[64:79], v[48:51], v[128:131], 0
  ds_read_b64_tr_b16 v[36:37], v33 offset:4096
  ds_read_b64_tr_b16 v[38:39], v33 offset:4608
  s_waitcnt lgkmcnt(6)
  v_mfma_f32_32x32x16_bf16 v[80:95], v[52:55], v[128:131], 0
  ds_read_b64_tr_b16 v[40:41], v34 offset:4096
  ds_read_b64_tr_b16 v[42:43], v34 offset:4608
  s_lshl_b32 s52, s34, 10
  s_add_u32 m0, s52, 49152
  s_add_u32 s53, s52, 57344
  buffer_load_dwordx4 v3, s[12:15], s39 offen lds
  s_mov_b32 m0, s53
  s_add_u32 s39, s39, s41
  buffer_load_dwordx4 v4, s[16:19], s40 offen lds
  s_add_u32 s40, s40, s41
  s_waitcnt lgkmcnt(6)
  v_mfma_f32_32x32x16_bf16 v[64:79], v[56:59], v[132:135], v[64:79]
  ds_read_b64_tr_b16 v[48:49], v33 offset:6144
  ds_read_b64_tr_b16 v[50:51], v33 offset:6656
  s_waitcnt lgkmcnt(6)
  v_mfma_f32_32x32x16_bf16 v[80:95], v[60:63], v[132:135], v[80:95]
  ds_read_b64_tr_b16 v[52:53], v34 offset:6144
  ds_read_b64_tr_b16 v[54:55], v34 offset:6656
  s_waitcnt lgkmcnt(6)
  v_mfma_f32_32x32x16_bf16 v[64:79], v[36:39], v[136:139], v[64:79]
  ds_read_b64_tr_b16 v[56:57], v33 offset:16384
  ds_read_b64_tr_b16 v[58:59], v33 offset:16896
  s_waitcnt lgkmcnt(6)
  v_mfma_f32_32x32x16_bf16 v[80:95], v[40:43], v[136:139], v[80:95]
  ds_read_b64_tr_b16 v[60:61], v34 offset:16384
  ds_read_b64_tr_b16 v[62:63], v34 offset:16896
  s_waitcnt lgkmcnt(6)
  v_mfma_f32_32x32x16_bf16 v[64:79], v[48:51], v[140:143], v[64:79]
  ds_read_b64_tr_b16 v[36:37], v33 offset:18432
  ds_read_b64_tr_b16 v[38:39], v33 offset:18944
  s_waitcnt lgkmcnt(6)
  v_mfma_f32_32x32x16_bf16 v[80:95], v[52:55], v[140:143], v[80:95]
  ds_read_b64_tr_b16 v[40:41], v34 offset:18432
  ds_read_b64_tr_b16 v[42:43], v34 offset:18944
  s_waitcnt vmcnt(6)
  s_sub_u32 s52, s2, 128
  s_cmp_lt_u32 s52, 24
  s_cbranch_scc0 parallel_sum__mha_block__glu_gated_swiglu__prompt_kernel_j2w_7
  s_waitcnt vmcnt(8)
parallel_sum__mha_block__glu_gated_swiglu__prompt_kernel_j2w_7:
  s_barrier
  s_sub_u32 s77, s2, 128
  s_cmp_lt_u32 s77, 24
  s_cbranch_scc0 parallel_sum__mha_block__glu_gated_swiglu__prompt_kernel_sg0_8
  s_cmp_eq_u32 s34, 0
  s_cbranch_scc0 parallel_sum__mha_block__glu_gated_swiglu__prompt_kernel_sg0_8
  s_lshl_b32 s77, s77, 2
  s_add_u32 s77, s77, 24654848
  v_mov_b32 v28, s74
  v_mov_b32 v29, 0
  buffer_store_dword v28, v29, s[20:23], s77 offen sc1
parallel_sum__mha_block__glu_gated_swiglu__prompt_kernel_sg0_8:
  s_waitcnt lgkmcnt(6)
  v_mfma_f32_32x32x16_bf16 v[64:79], v[56:59], v[144:147], v[64:79]
  ds_read_b64_tr_b16 v[48:49], v33 offset:20480
  ds_read_b64_tr_b16 v[50:51], v33 offset:20992
  s_waitcnt lgkmcnt(6)
  v_mfma_f32_32x32x16_bf16 v[80:95], v[60:63], v[144:147], v[80:95]
  ds_read_b64_tr_b16 v[52:53], v34 offset:20480
  ds_read_b64_tr_b16 v[54:55], v34 offset:20992
  s_lshl_b32 s52, s34, 10
  s_add_u32 m0, s52, 65536
  s_add_u32 s53, s52, 73728
  buffer_load_dwordx4 v3, s[12:15], s39 offen lds
  s_mov_b32 m0, s53
  s_add_u32 s39, s39, s41
  buffer_load_dwordx4 v4, s[16:19], s40 offen lds
  s_add_u32 s40, s40, s41
  s_waitcnt lgkmcnt(6)
  v_mfma_f32_32x32x16_bf16 v[64:79], v[36:39], v[148:151], v[64:79]
  ds_read_b64_tr_b16 v[56:57], v33 offset:22528
  ds_read_b64_tr_b16 v[58:59], v33 offset:23040
  s_waitcnt lgkmcnt(6)
  v_mfma_f32_32x32x16_bf16 v[80:95], v[40:43], v[148:151], v[80:95]
  ds_read_b64_tr_b16 v[60:61], v34 offset:22528
  ds_read_b64_tr_b16 v[62:63], v34 offset:23040
  s_waitcnt lgkmcnt(6)
  v_mfma_f32_32x32x16_bf16 v[64:79], v[48:51], v[152:155], v[64:79]
  ds_read_b64_tr_b16 v[36:37], v5 offset:0
  ds_read_b64_tr_b16 v[38:39], v5 offset:512
  s_waitcnt lgkmcnt(6)
  v_mfma_f32_32x32x16_bf16 v[80:95], v[52:55], v[152:155], v[80:95]
  ds_read_b64_tr_b16 v[40:41], v6 offset:0
  ds_read_b64_tr_b16 v[42:43], v6 offset:512
  s_waitcnt lgkmcnt(6)
  v_mfma_f32_32x32x16_bf16 v[64:79], v[56:59], v[156:159], v[64:79]
  ds_read_b64_tr_b16 v[48:49], v5 offset:2048
  ds_read_b64_tr_b16 v[50:51], v5 offset:2560
  s_waitcnt lgkmcnt(6)
  v_mfma_f32_32x32x16_bf16 v[80:95], v[60:63], v[156:159], v[80:95]
  ds_read_b64_tr_b16 v[52:53], v6 offset:2048
  ds_read_b64_tr_b16 v[54:55], v6 offset:2560
  s_waitcnt vmcnt(6)
  s_barrier
  s_waitcnt lgkmcnt(6)
  v_mfma_f32_32x32x16_bf16 v[64:79], v[36:39], v[160:163], v[64:79]
  ds_read_b64_tr_b16 v[56:57], v5 offset:4096
  ds_read_b64_tr_b16 v[58:59], v5 offset:4608
  s_waitcnt lgkmcnt(6)
  v_mfma_f32_32x32x16_bf16 v[80:95], v[40:43], v[160:163], v[80:95]
  ds_read_b64_tr_b16 v[60:61], v6 offset:4096
  ds_read_b64_tr_b16 v[62:63], v6 offset:4608
  s_lshl_b32 s52, s34, 10
  s_add_u32 m0, s52, 81920
  s_add_u32 s53, s52, 90112
  buffer_load_dwordx4 v3, s[12:15], s39 offen lds
  s_mov_b32 m0, s53
  s_add_u32 s39, s39, s41
  buffer_load_dwordx4 v4, s[16:19], s40 offen lds
  s_add_u32 s40, s40, s41
  s_waitcnt lgkmcnt(6)
  v_mfma_f32_32x32x16_bf16 v[64:79], v[48:51], v[164:167], v[64:79]
  ds_read_b64_tr_b16 v[36:37], v5 offset:6144
  ds_read_b64_tr_b16 v[38:39], v5 offset:6656
  s_waitcnt lgkmcnt(6)
  v_mfma_f32_32x32x16_bf16 v[80:95], v[52:55], v[164:167], v[80:95]
  ds_read_b64_tr_b16 v[40:41], v6 offset:6144
  ds_read_b64_tr_b16 v[42:43], v6 offset:6656
  s_waitcnt lgkmcnt(6)
  v_mfma_f32_32x32x16_bf16 v[64:79], v[56:59], v[168:171], v[64:79]
  ds_read_b64_tr_b16 v[48:49], v5 offset:16384
  ds_read_b64_tr_b16 v[50:51], v5 offset:16896
  s_waitcnt lgkmcnt(6)
  v_mfma_f32_32x32x16_bf16 v[80:95], v[60:63], v[168:171], v[80:95]
  ds_read_b64_tr_b16 v[52:53], v6 offset:16384
  ds_read_b64_tr_b16 v[54:55], v6 offset:16896
  s_waitcnt lgkmcnt(6)
  v_mfma_f32_32x32x16_bf16 v[64:79], v[36:39], v[172:175], v[64:79]
  ds_read_b64_tr_b16 v[56:57], v5 offset:18432
  ds_read_b64_tr_b16 v[58:59], v5 offset:18944
  s_waitcnt lgkmcnt(6)
  v_mfma_f32_32x32x16_bf16 v[80:95], v[40:43], v[172:175], v[80:95]
  ds_read_b64_tr_b16 v[60:61], v6 offset:18432
  ds_read_b64_tr_b16 v[62:63], v6 offset:18944
  s_waitcnt vmcnt(6)
  s_barrier
  s_waitcnt lgkmcnt(6)
  v_mfma_f32_32x32x16_bf16 v[64:79], v[48:51], v[176:179], v[64:79]
  ds_read_b64_tr_b16 v[36:37], v5 offset:20480
  ds_read_b64_tr_b16 v[38:39], v5 offset:20992
  s_waitcnt lgkmcnt(6)
  v_mfma_f32_32x32x16_bf16 v[80:95], v[52:55], v[176:179], v[80:95]
  ds_read_b64_tr_b16 v[40:41], v6 offset:20480
  ds_read_b64_tr_b16 v[42:43], v6 offset:20992
  s_mov_b32 s39, s58
  s_mov_b32 s40, s58
  s_mov_b32 s12, s26
  s_mov_b32 s13, s27
  s_mov_b32 s14, 1409024
  s_mov_b32 s15, 0x20000
  s_mov_b32 s16, s28
  s_mov_b32 s17, s29
  s_mov_b32 s18, 1409024
  s_mov_b32 s19, 0x20000
  s_mov_b32 s41, 176128
  v_mov_b32 v3, v45
  v_mov_b32 v4, v47
  s_lshl_b32 s52, s34, 10
  s_add_u32 m0, s52, 98304
  s_add_u32 s53, s52, 106496
  buffer_load_dwordx4 v3, s[12:15], s39 offen lds
  s_mov_b32 m0, s53
  s_add_u32 s39, s39, s41
  buffer_load_dwordx4 v4, s[16:19], s40 offen lds
  s_add_u32 s40, s40, s41
  s_waitcnt lgkmcnt(6)
  v_mfma_f32_32x32x16_bf16 v[64:79], v[56:59], v[180:183], v[64:79]
  ds_read_b64_tr_b16 v[48:49], v5 offset:22528
  ds_read_b64_tr_b16 v[50:51], v5 offset:23040
  s_waitcnt lgkmcnt(6)
  v_mfma_f32_32x32x16_bf16 v[80:95], v[60:63], v[180:183], v[80:95]
  ds_read_b64_tr_b16 v[52:53], v6 offset:22528
  ds_read_b64_tr_b16 v[54:55], v6 offset:23040
  s_waitcnt lgkmcnt(6)
  v_mfma_f32_32x32x16_bf16 v[64:79], v[36:39], v[184:187], v[64:79]
  ds_read_b64_tr_b16 v[56:57], v5 offset:32768
  ds_read_b64_tr_b16 v[58:59], v5 offset:33280
  s_waitcnt lgkmcnt(6)
  v_mfma_f32_32x32x16_bf16 v[80:95], v[40:43], v[184:187], v[80:95]
  ds_read_b64_tr_b16 v[60:61], v6 offset:32768
  ds_read_b64_tr_b16 v[62:63], v6 offset:33280
  s_waitcnt lgkmcnt(6)
  v_mfma_f32_32x32x16_bf16 v[64:79], v[48:51], v[188:191], v[64:79]
  ds_read_b64_tr_b16 v[36:37], v5 offset:34816
  ds_read_b64_tr_b16 v[38:39], v5 offset:35328
  s_waitcnt lgkmcnt(6)
  v_mfma_f32_32x32x16_bf16 v[80:95], v[52:55], v[188:191], v[80:95]
  ds_read_b64_tr_b16 v[40:41], v6 offset:34816
  ds_read_b64_tr_b16 v[42:43], v6 offset:35328
  s_waitcnt vmcnt(6)
  s_barrier
  s_waitcnt lgkmcnt(6)
  v_mfma_f32_32x32x16_bf16 v[64:79], v[56:59], v[192:195], v[64:79]
  ds_read_b64_tr_b16 v[48:49], v5 offset:36864
  ds_read_b64_tr_b16 v[50:51], v5 offset:37376
  s_waitcnt lgkmcnt(6)
  v_mfma_f32_32x32x16_bf16 v[80:95], v[60:63], v[192:195], v[80:95]
  ds_read_b64_tr_b16 v[52:53], v6 offset:36864
  ds_read_b64_tr_b16 v[54:55], v6 offset:37376
  s_lshl_b32 s52, s34, 10
  s_add_u32 m0, s52, 114688
  s_add_u32 s53, s52, 122880
  buffer_load_dwordx4 v3, s[12:15], s39 offen lds
  s_mov_b32 m0, s53
  s_add_u32 s39, s39, s41
  buffer_load_dwordx4 v4, s[16:19], s40 offen lds
  s_add_u32 s40, s40, s41
  s_waitcnt lgkmcnt(6)
  v_mfma_f32_32x32x16_bf16 v[64:79], v[36:39], v[196:199], v[64:79]
  ds_read_b64_tr_b16 v[56:57], v5 offset:38912
  ds_read_b64_tr_b16 v[58:59], v5 offset:39424
  s_waitcnt lgkmcnt(6)
  v_mfma_f32_32x32x16_bf16 v[80:95], v[40:43], v[196:199], v[80:95]
  ds_read_b64_tr_b16 v[60:61], v6 offset:38912
  ds_read_b64_tr_b16 v[62:63], v6 offset:39424
  s_waitcnt lgkmcnt(6)
  v_mfma_f32_32x32x16_bf16 v[64:79], v[48:51], v[200:203], v[64:79]
  ds_read_b64_tr_b16 v[36:37], v5 offset:49152
  ds_read_b64_tr_b16 v[38:39], v5 offset:49664
  s_waitcnt lgkmcnt(6)
  v_mfma_f32_32x32x16_bf16 v[80:95], v[52:55], v[200:203], v[80:95]
  ds_read_b64_tr_b16 v[40:41], v6 offset:49152
  ds_read_b64_tr_b16 v[42:43], v6 offset:49664
  s_waitcnt lgkmcnt(6)
  v_mfma_f32_32x32x16_bf16 v[64:79], v[56:59], v[204:207], v[64:79]
  ds_read_b64_tr_b16 v[48:49], v5 offset:51200
  ds_read_b64_tr_b16 v[50:51], v5 offset:51712
  s_waitcnt lgkmcnt(6)
  v_mfma_f32_32x32x16_bf16 v[80:95], v[60:63], v[204:207], v[80:95]
  ds_read_b64_tr_b16 v[52:53], v6 offset:51200
  ds_read_b64_tr_b16 v[54:55], v6 offset:51712
  s_waitcnt vmcnt(6)
  s_barrier
  s_waitcnt lgkmcnt(6)
  v_mfma_f32_32x32x16_bf16 v[64:79], v[36:39], v[208:211], v[64:79]
  ds_read_b64_tr_b16 v[56:57], v5 offset:53248
  ds_read_b64_tr_b16 v[58:59], v5 offset:53760
  s_waitcnt lgkmcnt(6)
  v_mfma_f32_32x32x16_bf16 v[80:95], v[40:43], v[208:211], v[80:95]
  ds_read_b64_tr_b16 v[60:61], v6 offset:53248
  ds_read_b64_tr_b16 v[62:63], v6 offset:53760
  s_lshl_b32 s52, s34, 10
  s_add_u32 m0, s52, 131072
  s_add_u32 s53, s52, 139264
  buffer_load_dwordx4 v3, s[12:15], s39 offen lds
  s_mov_b32 m0, s53
  s_add_u32 s39, s39, s41
  buffer_load_dwordx4 v4, s[16:19], s40 offen lds
  s_add_u32 s40, s40, s41
  s_add_u32 s54, s39, s41
  s_add_u32 s54, s54, s41
  s_lshl_b32 s52, s34, 10
  s_add_u32 m0, s52, 16384
  s_add_u32 s53, s52, 24576
  buffer_load_dwordx4 v3, s[12:15], s54 offen lds
  s_mov_b32 m0, s53
  s_nop 0
  buffer_load_dwordx4 v4, s[16:19], s54 offen lds
  s_waitcnt lgkmcnt(6)
  v_mfma_f32_32x32x16_bf16 v[64:79], v[48:51], v[212:215], v[64:79]
  ds_read_b64_tr_b16 v[36:37], v5 offset:55296
  ds_read_b64_tr_b16 v[38:39], v5 offset:55808
  s_waitcnt lgkmcnt(6)
  v_mfma_f32_32x32x16_bf16 v[80:95], v[52:55], v[212:215], v[80:95]
  ds_read_b64_tr_b16 v[40:41], v6 offset:55296
  ds_read_b64_tr_b16 v[42:43], v6 offset:55808
  s_waitcnt lgkmcnt(6)
  v_mfma_f32_32x32x16_bf16 v[64:79], v[56:59], v[216:219], v[64:79]
  ds_read_b64_tr_b16 v[48:49], v7 offset:0
  ds_read_b64_tr_b16 v[50:51], v7 offset:512
  s_waitcnt lgkmcnt(6)
  v_mfma_f32_32x32x16_bf16 v[80:95], v[60:63], v[216:219], v[80:95]
  ds_read_b64_tr_b16 v[52:53], v8 offset:0
  ds_read_b64_tr_b16 v[54:55], v8 offset:512
  s_waitcnt lgkmcnt(6)
  v_mfma_f32_32x32x16_bf16 v[64:79], v[36:39], v[220:223], v[64:79]
  ds_read_b64_tr_b16 v[56:57], v7 offset:2048
  ds_read_b64_tr_b16 v[58:59], v7 offset:2560
  s_waitcnt lgkmcnt(6)
  v_mfma_f32_32x32x16_bf16 v[80:95], v[40:43], v[220:223], v[80:95]
  ds_read_b64_tr_b16 v[60:61], v8 offset:2048
  ds_read_b64_tr_b16 v[62:63], v8 offset:2560
  s_waitcnt vmcnt(8)
  s_barrier
  s_waitcnt lgkmcnt(6)
  v_mfma_f32_32x32x16_bf16 v[64:79], v[48:51], v[224:227], v[64:79]
  ds_read_b64_tr_b16 v[36:37], v7 offset:4096
  ds_read_b64_tr_b16 v[38:39], v7 offset:4608
  s_waitcnt lgkmcnt(6)
  v_mfma_f32_32x32x16_bf16 v[80:95], v[52:55], v[224:227], v[80:95]
  ds_read_b64_tr_b16 v[40:41], v8 offset:4096
  ds_read_b64_tr_b16 v[42:43], v8 offset:4608
  s_lshl_b32 s52, s34, 10
  s_add_u32 m0, s52, 147456
  s_add_u32 s53, s52, 155648
  buffer_load_dwordx4 v3, s[12:15], s39 offen lds
  s_mov_b32 m0, s53
  s_add_u32 s39, s39, s41
  buffer_load_dwordx4 v4, s[16:19], s40 offen lds
  s_add_u32 s40, s40, s41
  s_add_u32 s54, s39, s41
  s_add_u32 s54, s54, s41
  s_lshl_b32 s52, s34, 10
  s_add_u32 m0, s52, 32768
  s_add_u32 s53, s52, 40960
  buffer_load_dwordx4 v3, s[12:15], s54 offen lds
  s_mov_b32 m0, s53
  s_nop 0
  buffer_load_dwordx4 v4, s[16:19], s54 offen lds
  s_waitcnt lgkmcnt(6)
  v_mfma_f32_32x32x16_bf16 v[64:79], v[56:59], v[228:231], v[64:79]
  ds_read_b64_tr_b16 v[48:49], v7 offset:6144
  ds_read_b64_tr_b16 v[50:51], v7 offset:6656
  s_waitcnt lgkmcnt(6)
  v_mfma_f32_32x32x16_bf16 v[80:95], v[60:63], v[228:231], v[80:95]
  ds_read_b64_tr_b16 v[52:53], v8 offset:6144
  ds_read_b64_tr_b16 v[54:55], v8 offset:6656
  s_waitcnt lgkmcnt(6)
  v_mfma_f32_32x32x16_bf16 v[64:79], v[36:39], v[232:235], v[64:79]
  ds_read_b64_tr_b16 v[56:57], v7 offset:16384
  ds_read_b64_tr_b16 v[58:59], v7 offset:16896
  s_waitcnt lgkmcnt(6)
  v_mfma_f32_32x32x16_bf16 v[80:95], v[40:43], v[232:235], v[80:95]
  ds_read_b64_tr_b16 v[60:61], v8 offset:16384
  ds_read_b64_tr_b16 v[62:63], v8 offset:16896
  s_waitcnt lgkmcnt(6)
  v_mfma_f32_32x32x16_bf16 v[64:79], v[48:51], v[236:239], v[64:79]
  ds_read_b64_tr_b16 v[36:37], v7 offset:18432
  ds_read_b64_tr_b16 v[38:39], v7 offset:18944
  s_waitcnt lgkmcnt(6)
  v_mfma_f32_32x32x16_bf16 v[80:95], v[52:55], v[236:239], v[80:95]
  ds_read_b64_tr_b16 v[40:41], v8 offset:18432
  ds_read_b64_tr_b16 v[42:43], v8 offset:18944
  s_waitcnt vmcnt(10)
  s_barrier
  s_waitcnt lgkmcnt(6)
  v_mfma_f32_32x32x16_bf16 v[64:79], v[56:59], v[240:243], v[64:79]
  ds_read_b64_tr_b16 v[48:49], v7 offset:20480
  ds_read_b64_tr_b16 v[50:51], v7 offset:20992
  s_waitcnt lgkmcnt(6)
  v_mfma_f32_32x32x16_bf16 v[80:95], v[60:63], v[240:243], v[80:95]
  ds_read_b64_tr_b16 v[52:53], v8 offset:20480
  ds_read_b64_tr_b16 v[54:55], v8 offset:20992
  s_lshl_b32 s52, s34, 10
  s_add_u32 m0, s52, 0
  s_add_u32 s53, s52, 8192
  buffer_load_dwordx4 v3, s[12:15], s39 offen lds
  s_mov_b32 m0, s53
  s_add_u32 s39, s39, s41
  buffer_load_dwordx4 v4, s[16:19], s40 offen lds
  s_add_u32 s40, s40, s41
  s_add_u32 s54, s39, s41
  s_add_u32 s54, s54, s41
  s_lshl_b32 s52, s34, 10
  s_add_u32 m0, s52, 49152
  s_add_u32 s53, s52, 57344
  buffer_load_dwordx4 v3, s[12:15], s54 offen lds
  s_mov_b32 m0, s53
  s_nop 0
  buffer_load_dwordx4 v4, s[16:19], s54 offen lds
  s_waitcnt lgkmcnt(6)
  v_mfma_f32_32x32x16_bf16 v[64:79], v[36:39], v[244:247], v[64:79]
  ds_read_b64_tr_b16 v[56:57], v7 offset:22528
  ds_read_b64_tr_b16 v[58:59], v7 offset:23040
  s_waitcnt lgkmcnt(6)
  v_mfma_f32_32x32x16_bf16 v[80:95], v[40:43], v[244:247], v[80:95]
  ds_read_b64_tr_b16 v[60:61], v8 offset:22528
  ds_read_b64_tr_b16 v[62:63], v8 offset:23040
  s_waitcnt lgkmcnt(6)
  v_mfma_f32_32x32x16_bf16 v[64:79], v[48:51], v[248:251], v[64:79]
  ds_read_b64_tr_b16 v[36:37], v7 offset:32768
  ds_read_b64_tr_b16 v[38:39], v7 offset:33280
  s_waitcnt lgkmcnt(6)
  v_mfma_f32_32x32x16_bf16 v[80:95], v[52:55], v[248:251], v[80:95]
  ds_read_b64_tr_b16 v[40:41], v7 offset:34816
  ds_read_b64_tr_b16 v[42:43], v7 offset:35328
  s_waitcnt lgkmcnt(6)
  v_mfma_f32_32x32x16_bf16 v[64:79], v[56:59], v[252:255], v[64:79]
  ds_read_b64_tr_b16 v[48:49], v7 offset:36864
  ds_read_b64_tr_b16 v[50:51], v7 offset:37376
  s_waitcnt lgkmcnt(6)
  v_mfma_f32_32x32x16_bf16 v[80:95], v[60:63], v[252:255], v[80:95]
  ds_read_b64_tr_b16 v[52:53], v7 offset:38912
  ds_read_b64_tr_b16 v[54:55], v7 offset:39424
  s_branch parallel_sum__mha_block__glu_gated_swiglu__prompt_kernel_i1
parallel_sum__mha_block__glu_gated_swiglu__prompt_kernel_i0s:
  s_waitcnt lgkmcnt(6)
  v_mfma_f32_32x32x16_bf16 v[64:79], v[128:131], v[48:51], 0
  ds_read_b64_tr_b16 v[36:37], v33 offset:4096
  ds_read_b64_tr_b16 v[38:39], v33 offset:4608
  s_waitcnt lgkmcnt(6)
  v_mfma_f32_32x32x16_bf16 v[80:95], v[128:131], v[52:55], 0
  ds_read_b64_tr_b16 v[40:41], v34 offset:4096
  ds_read_b64_tr_b16 v[42:43], v34 offset:4608
  s_lshl_b32 s52, s34, 10
  s_add_u32 m0, s52, 49152
  s_add_u32 s53, s52, 57344
  buffer_load_dwordx4 v3, s[12:15], s39 offen lds
  s_mov_b32 m0, s53
  s_add_u32 s39, s39, s41
  buffer_load_dwordx4 v4, s[16:19], s40 offen lds
  s_add_u32 s40, s40, s41
  s_waitcnt lgkmcnt(6)
  v_mfma_f32_32x32x16_bf16 v[64:79], v[132:135], v[56:59], v[64:79]
  ds_read_b64_tr_b16 v[48:49], v33 offset:6144
  ds_read_b64_tr_b16 v[50:51], v33 offset:6656
  s_waitcnt lgkmcnt(6)
  v_mfma_f32_32x32x16_bf16 v[80:95], v[132:135], v[60:63], v[80:95]
  ds_read_b64_tr_b16 v[52:53], v34 offset:6144
  ds_read_b64_tr_b16 v[54:55], v34 offset:6656
  s_waitcnt lgkmcnt(6)
  v_mfma_f32_32x32x16_bf16 v[64:79], v[136:139], v[36:39], v[64:79]
  ds_read_b64_tr_b16 v[56:57], v33 offset:16384
  ds_read_b64_tr_b16 v[58:59], v33 offset:16896
  s_waitcnt lgkmcnt(6)
  v_mfma_f32_32x32x16_bf16 v[80:95], v[136:139], v[40:43], v[80:95]
  ds_read_b64_tr_b16 v[60:61], v34 offset:16384
  ds_read_b64_tr_b16 v[62:63], v34 offset:16896
  s_waitcnt lgkmcnt(6)
  v_mfma_f32_32x32x16_bf16 v[64:79], v[140:143], v[48:51], v[64:79]
  ds_read_b64_tr_b16 v[36:37], v33 offset:18432
  ds_read_b64_tr_b16 v[38:39], v33 offset:18944
  s_waitcnt lgkmcnt(6)
  v_mfma_f32_32x32x16_bf16 v[80:95], v[140:143], v[52:55], v[80:95]
  ds_read_b64_tr_b16 v[40:41], v34 offset:18432
  ds_read_b64_tr_b16 v[42:43], v34 offset:18944
  s_waitcnt vmcnt(6)
  s_sub_u32 s52, s2, 128
  s_cmp_lt_u32 s52, 24
  s_cbranch_scc0 parallel_sum__mha_block__glu_gated_swiglu__prompt_kernel_j2w_9
  s_waitcnt vmcnt(8)
parallel_sum__mha_block__glu_gated_swiglu__prompt_kernel_j2w_9:
  s_barrier
  s_sub_u32 s77, s2, 128
  s_cmp_lt_u32 s77, 24
  s_cbranch_scc0 parallel_sum__mha_block__glu_gated_swiglu__prompt_kernel_sg0_10
  s_cmp_eq_u32 s34, 0
  s_cbranch_scc0 parallel_sum__mha_block__glu_gated_swiglu__prompt_kernel_sg0_10
  s_lshl_b32 s77, s77, 2
  s_add_u32 s77, s77, 24654848
  v_mov_b32 v28, s74
  v_mov_b32 v29, 0
  buffer_store_dword v28, v29, s[20:23], s77 offen sc1
parallel_sum__mha_block__glu_gated_swiglu__prompt_kernel_sg0_10:
  s_waitcnt lgkmcnt(6)
  v_mfma_f32_32x32x16_bf16 v[64:79], v[144:147], v[56:59], v[64:79]
  ds_read_b64_tr_b16 v[48:49], v33 offset:20480
  ds_read_b64_tr_b16 v[50:51], v33 offset:20992
  s_waitcnt lgkmcnt(6)
  v_mfma_f32_32x32x16_bf16 v[80:95], v[144:147], v[60:63], v[80:95]
  ds_read_b64_tr_b16 v[52:53], v34 offset:20480
  ds_read_b64_tr_b16 v[54:55], v34 offset:20992
  s_lshl_b32 s52, s34, 10
  s_add_u32 m0, s52, 65536
  s_add_u32 s53, s52, 73728
  buffer_load_dwordx4 v3, s[12:15], s39 offen lds
  s_mov_b32 m0, s53
  s_add_u32 s39, s39, s41
  buffer_load_dwordx4 v4, s[16:19], s40 offen lds
  s_add_u32 s40, s40, s41
  s_waitcnt lgkmcnt(6)
  v_mfma_f32_32x32x16_bf16 v[64:79], v[148:151], v[36:39], v[64:79]
  ds_read_b64_tr_b16 v[56:57], v33 offset:22528
  ds_read_b64_tr_b16 v[58:59], v33 offset:23040
  s_waitcnt lgkmcnt(6)
  v_mfma_f32_32x32x16_bf16 v[80:95], v[148:151], v[40:43], v[80:95]
  ds_read_b64_tr_b16 v[60:61], v34 offset:22528
  ds_read_b64_tr_b16 v[62:63], v34 offset:23040
  s_waitcnt lgkmcnt(6)
  v_mfma_f32_32x32x16_bf16 v[64:79], v[152:155], v[48:51], v[64:79]
  ds_read_b64_tr_b16 v[36:37], v5 offset:0
  ds_read_b64_tr_b16 v[38:39], v5 offset:512
  s_waitcnt lgkmcnt(6)
  v_mfma_f32_32x32x16_bf16 v[80:95], v[152:155], v[52:55], v[80:95]
  ds_read_b64_tr_b16 v[40:41], v6 offset:0
  ds_read_b64_tr_b16 v[42:43], v6 offset:512
  s_waitcnt lgkmcnt(6)
  v_mfma_f32_32x32x16_bf16 v[64:79], v[156:159], v[56:59], v[64:79]
  ds_read_b64_tr_b16 v[48:49], v5 offset:2048
  ds_read_b64_tr_b16 v[50:51], v5 offset:2560
  s_waitcnt lgkmcnt(6)
  v_mfma_f32_32x32x16_bf16 v[80:95], v[156:159], v[60:63], v[80:95]
  ds_read_b64_tr_b16 v[52:53], v6 offset:2048
  ds_read_b64_tr_b16 v[54:55], v6 offset:2560
  s_waitcnt vmcnt(6)
  s_barrier
  s_waitcnt lgkmcnt(6)
  v_mfma_f32_32x32x16_bf16 v[64:79], v[160:163], v[36:39], v[64:79]
  ds_read_b64_tr_b16 v[56:57], v5 offset:4096
  ds_read_b64_tr_b16 v[58:59], v5 offset:4608
  s_waitcnt lgkmcnt(6)
  v_mfma_f32_32x32x16_bf16 v[80:95], v[160:163], v[40:43], v[80:95]
  ds_read_b64_tr_b16 v[60:61], v6 offset:4096
  ds_read_b64_tr_b16 v[62:63], v6 offset:4608
  s_lshl_b32 s52, s34, 10
  s_add_u32 m0, s52, 81920
  s_add_u32 s53, s52, 90112
  buffer_load_dwordx4 v3, s[12:15], s39 offen lds
  s_mov_b32 m0, s53
  s_add_u32 s39, s39, s41
  buffer_load_dwordx4 v4, s[16:19], s40 offen lds
  s_add_u32 s40, s40, s41
  s_waitcnt lgkmcnt(6)
  v_mfma_f32_32x32x16_bf16 v[64:79], v[164:167], v[48:51], v[64:79]
  ds_read_b64_tr_b16 v[36:37], v5 offset:6144
  ds_read_b64_tr_b16 v[38:39], v5 offset:6656
  s_waitcnt lgkmcnt(6)
  v_mfma_f32_32x32x16_bf16 v[80:95], v[164:167], v[52:55], v[80:95]
  ds_read_b64_tr_b16 v[40:41], v6 offset:6144
  ds_read_b64_tr_b16 v[42:43], v6 offset:6656
  s_waitcnt lgkmcnt(6)
  v_mfma_f32_32x32x16_bf16 v[64:79], v[168:171], v[56:59], v[64:79]
  ds_read_b64_tr_b16 v[48:49], v5 offset:16384
  ds_read_b64_tr_b16 v[50:51], v5 offset:16896
  s_waitcnt lgkmcnt(6)
  v_mfma_f32_32x32x16_bf16 v[80:95], v[168:171], v[60:63], v[80:95]
  ds_read_b64_tr_b16 v[52:53], v6 offset:16384
  ds_read_b64_tr_b16 v[54:55], v6 offset:16896
  s_waitcnt lgkmcnt(6)
  v_mfma_f32_32x32x16_bf16 v[64:79], v[172:175], v[36:39], v[64:79]
  ds_read_b64_tr_b16 v[56:57], v5 offset:18432
  ds_read_b64_tr_b16 v[58:59], v5 offset:18944
  s_waitcnt lgkmcnt(6)
  v_mfma_f32_32x32x16_bf16 v[80:95], v[172:175], v[40:43], v[80:95]
  ds_read_b64_tr_b16 v[60:61], v6 offset:18432
  ds_read_b64_tr_b16 v[62:63], v6 offset:18944
  s_waitcnt vmcnt(6)
  s_barrier
  s_waitcnt lgkmcnt(6)
  v_mfma_f32_32x32x16_bf16 v[64:79], v[176:179], v[48:51], v[64:79]
  ds_read_b64_tr_b16 v[36:37], v5 offset:20480
  ds_read_b64_tr_b16 v[38:39], v5 offset:20992
  s_waitcnt lgkmcnt(6)
  v_mfma_f32_32x32x16_bf16 v[80:95], v[176:179], v[52:55], v[80:95]
  ds_read_b64_tr_b16 v[40:41], v6 offset:20480
  ds_read_b64_tr_b16 v[42:43], v6 offset:20992
  s_mov_b32 s39, s58
  s_mov_b32 s40, s58
  s_mov_b32 s12, s26
  s_mov_b32 s13, s27
  s_mov_b32 s14, 1409024
  s_mov_b32 s15, 0x20000
  s_mov_b32 s16, s28
  s_mov_b32 s17, s29
  s_mov_b32 s18, 1409024
  s_mov_b32 s19, 0x20000
  s_mov_b32 s41, 176128
  v_mov_b32 v3, v45
  v_mov_b32 v4, v47
  s_lshl_b32 s52, s34, 10
  s_add_u32 m0, s52, 98304
  s_add_u32 s53, s52, 106496
  buffer_load_dwordx4 v3, s[12:15], s39 offen lds
  s_mov_b32 m0, s53
  s_add_u32 s39, s39, s41
  buffer_load_dwordx4 v4, s[16:19], s40 offen lds
  s_add_u32 s40, s40, s41
  s_waitcnt lgkmcnt(6)
  v_mfma_f32_32x32x16_bf16 v[64:79], v[180:183], v[56:59], v[64:79]
  ds_read_b64_tr_b16 v[48:49], v5 offset:22528
  ds_read_b64_tr_b16 v[50:51], v5 offset:23040
  s_waitcnt lgkmcnt(6)
  v_mfma_f32_32x32x16_bf16 v[80:95], v[180:183], v[60:63], v[80:95]
  ds_read_b64_tr_b16 v[52:53], v6 offset:22528
  ds_read_b64_tr_b16 v[54:55], v6 offset:23040
  s_waitcnt lgkmcnt(6)
  v_mfma_f32_32x32x16_bf16 v[64:79], v[184:187], v[36:39], v[64:79]
  ds_read_b64_tr_b16 v[56:57], v5 offset:32768
  ds_read_b64_tr_b16 v[58:59], v5 offset:33280
  s_waitcnt lgkmcnt(6)
  v_mfma_f32_32x32x16_bf16 v[80:95], v[184:187], v[40:43], v[80:95]
  ds_read_b64_tr_b16 v[60:61], v6 offset:32768
  ds_read_b64_tr_b16 v[62:63], v6 offset:33280
  s_waitcnt lgkmcnt(6)
  v_mfma_f32_32x32x16_bf16 v[64:79], v[188:191], v[48:51], v[64:79]
  ds_read_b64_tr_b16 v[36:37], v5 offset:34816
  ds_read_b64_tr_b16 v[38:39], v5 offset:35328
  s_waitcnt lgkmcnt(6)
  v_mfma_f32_32x32x16_bf16 v[80:95], v[188:191], v[52:55], v[80:95]
  ds_read_b64_tr_b16 v[40:41], v6 offset:34816
  ds_read_b64_tr_b16 v[42:43], v6 offset:35328
  s_waitcnt vmcnt(6)
  s_barrier
  s_waitcnt lgkmcnt(6)
  v_mfma_f32_32x32x16_bf16 v[64:79], v[192:195], v[56:59], v[64:79]
  ds_read_b64_tr_b16 v[48:49], v5 offset:36864
  ds_read_b64_tr_b16 v[50:51], v5 offset:37376
  s_waitcnt lgkmcnt(6)
  v_mfma_f32_32x32x16_bf16 v[80:95], v[192:195], v[60:63], v[80:95]
  ds_read_b64_tr_b16 v[52:53], v6 offset:36864
  ds_read_b64_tr_b16 v[54:55], v6 offset:37376
  s_lshl_b32 s52, s34, 10
  s_add_u32 m0, s52, 114688
  s_add_u32 s53, s52, 122880
  buffer_load_dwordx4 v3, s[12:15], s39 offen lds
  s_mov_b32 m0, s53
  s_add_u32 s39, s39, s41
  buffer_load_dwordx4 v4, s[16:19], s40 offen lds
  s_add_u32 s40, s40, s41
  s_waitcnt lgkmcnt(6)
  v_mfma_f32_32x32x16_bf16 v[64:79], v[196:199], v[36:39], v[64:79]
  ds_read_b64_tr_b16 v[56:57], v5 offset:38912
  ds_read_b64_tr_b16 v[58:59], v5 offset:39424
  s_waitcnt lgkmcnt(6)
  v_mfma_f32_32x32x16_bf16 v[80:95], v[196:199], v[40:43], v[80:95]
  ds_read_b64_tr_b16 v[60:61], v6 offset:38912
  ds_read_b64_tr_b16 v[62:63], v6 offset:39424
  s_waitcnt lgkmcnt(6)
  v_mfma_f32_32x32x16_bf16 v[64:79], v[200:203], v[48:51], v[64:79]
  ds_read_b64_tr_b16 v[36:37], v5 offset:49152
  ds_read_b64_tr_b16 v[38:39], v5 offset:49664
  s_waitcnt lgkmcnt(6)
  v_mfma_f32_32x32x16_bf16 v[80:95], v[200:203], v[52:55], v[80:95]
  ds_read_b64_tr_b16 v[40:41], v6 offset:49152
  ds_read_b64_tr_b16 v[42:43], v6 offset:49664
  s_waitcnt lgkmcnt(6)
  v_mfma_f32_32x32x16_bf16 v[64:79], v[204:207], v[56:59], v[64:79]
  ds_read_b64_tr_b16 v[48:49], v5 offset:51200
  ds_read_b64_tr_b16 v[50:51], v5 offset:51712
  s_waitcnt lgkmcnt(6)
  v_mfma_f32_32x32x16_bf16 v[80:95], v[204:207], v[60:63], v[80:95]
  ds_read_b64_tr_b16 v[52:53], v6 offset:51200
  ds_read_b64_tr_b16 v[54:55], v6 offset:51712
  s_waitcnt vmcnt(6)
  s_barrier
  s_waitcnt lgkmcnt(6)
  v_mfma_f32_32x32x16_bf16 v[64:79], v[208:211], v[36:39], v[64:79]
  ds_read_b64_tr_b16 v[56:57], v5 offset:53248
  ds_read_b64_tr_b16 v[58:59], v5 offset:53760
  s_waitcnt lgkmcnt(6)
  v_mfma_f32_32x32x16_bf16 v[80:95], v[208:211], v[40:43], v[80:95]
  ds_read_b64_tr_b16 v[60:61], v6 offset:53248
  ds_read_b64_tr_b16 v[62:63], v6 offset:53760
  s_lshl_b32 s52, s34, 10
  s_add_u32 m0, s52, 131072
  s_add_u32 s53, s52, 139264
  buffer_load_dwordx4 v3, s[12:15], s39 offen lds
  s_mov_b32 m0, s53
  s_add_u32 s39, s39, s41
  buffer_load_dwordx4 v4, s[16:19], s40 offen lds
  s_add_u32 s40, s40, s41
  s_add_u32 s54, s39, s41
  s_add_u32 s54, s54, s41
  s_lshl_b32 s52, s34, 10
  s_add_u32 m0, s52, 16384
  s_add_u32 s53, s52, 24576
  buffer_load_dwordx4 v3, s[12:15], s54 offen lds
  s_mov_b32 m0, s53
  s_nop 0
  buffer_load_dwordx4 v4, s[16:19], s54 offen lds
  s_waitcnt lgkmcnt(6)
  v_mfma_f32_32x32x16_bf16 v[64:79], v[212:215], v[48:51], v[64:79]
  ds_read_b64_tr_b16 v[36:37], v5 offset:55296
  ds_read_b64_tr_b16 v[38:39], v5 offset:55808
  s_waitcnt lgkmcnt(6)
  v_mfma_f32_32x32x16_bf16 v[80:95], v[212:215], v[52:55], v[80:95]
  ds_read_b64_tr_b16 v[40:41], v6 offset:55296
  ds_read_b64_tr_b16 v[42:43], v6 offset:55808
  s_waitcnt lgkmcnt(6)
  v_mfma_f32_32x32x16_bf16 v[64:79], v[216:219], v[56:59], v[64:79]
  ds_read_b64_tr_b16 v[48:49], v7 offset:0
  ds_read_b64_tr_b16 v[50:51], v7 offset:512
  s_waitcnt lgkmcnt(6)
  v_mfma_f32_32x32x16_bf16 v[80:95], v[216:219], v[60:63], v[80:95]
  ds_read_b64_tr_b16 v[52:53], v8 offset:0
  ds_read_b64_tr_b16 v[54:55], v8 offset:512
  s_waitcnt lgkmcnt(6)
  v_mfma_f32_32x32x16_bf16 v[64:79], v[220:223], v[36:39], v[64:79]
  ds_read_b64_tr_b16 v[56:57], v7 offset:2048
  ds_read_b64_tr_b16 v[58:59], v7 offset:2560
  s_waitcnt lgkmcnt(6)
  v_mfma_f32_32x32x16_bf16 v[80:95], v[220:223], v[40:43], v[80:95]
  ds_read_b64_tr_b16 v[60:61], v8 offset:2048
  ds_read_b64_tr_b16 v[62:63], v8 offset:2560
  s_waitcnt vmcnt(8)
  s_barrier
  s_waitcnt lgkmcnt(6)
  v_mfma_f32_32x32x16_bf16 v[64:79], v[224:227], v[48:51], v[64:79]
  ds_read_b64_tr_b16 v[36:37], v7 offset:4096
  ds_read_b64_tr_b16 v[38:39], v7 offset:4608
  s_waitcnt lgkmcnt(6)
  v_mfma_f32_32x32x16_bf16 v[80:95], v[224:227], v[52:55], v[80:95]
  ds_read_b64_tr_b16 v[40:41], v8 offset:4096
  ds_read_b64_tr_b16 v[42:43], v8 offset:4608
  s_lshl_b32 s52, s34, 10
  s_add_u32 m0, s52, 147456
  s_add_u32 s53, s52, 155648
  buffer_load_dwordx4 v3, s[12:15], s39 offen lds
  s_mov_b32 m0, s53
  s_add_u32 s39, s39, s41
  buffer_load_dwordx4 v4, s[16:19], s40 offen lds
  s_add_u32 s40, s40, s41
  s_add_u32 s54, s39, s41
  s_add_u32 s54, s54, s41
  s_lshl_b32 s52, s34, 10
  s_add_u32 m0, s52, 32768
  s_add_u32 s53, s52, 40960
  buffer_load_dwordx4 v3, s[12:15], s54 offen lds
  s_mov_b32 m0, s53
  s_nop 0
  buffer_load_dwordx4 v4, s[16:19], s54 offen lds
  s_waitcnt lgkmcnt(6)
  v_mfma_f32_32x32x16_bf16 v[64:79], v[228:231], v[56:59], v[64:79]
  ds_read_b64_tr_b16 v[48:49], v7 offset:6144
  ds_read_b64_tr_b16 v[50:51], v7 offset:6656
  s_waitcnt lgkmcnt(6)
  v_mfma_f32_32x32x16_bf16 v[80:95], v[228:231], v[60:63], v[80:95]
  ds_read_b64_tr_b16 v[52:53], v8 offset:6144
  ds_read_b64_tr_b16 v[54:55], v8 offset:6656
  s_waitcnt lgkmcnt(6)
  v_mfma_f32_32x32x16_bf16 v[64:79], v[232:235], v[36:39], v[64:79]
  ds_read_b64_tr_b16 v[56:57], v7 offset:16384
  ds_read_b64_tr_b16 v[58:59], v7 offset:16896
  s_waitcnt lgkmcnt(6)
  v_mfma_f32_32x32x16_bf16 v[80:95], v[232:235], v[40:43], v[80:95]
  ds_read_b64_tr_b16 v[60:61], v8 offset:16384
  ds_read_b64_tr_b16 v[62:63], v8 offset:16896
  s_waitcnt lgkmcnt(6)
  v_mfma_f32_32x32x16_bf16 v[64:79], v[236:239], v[48:51], v[64:79]
  ds_read_b64_tr_b16 v[36:37], v7 offset:18432
  ds_read_b64_tr_b16 v[38:39], v7 offset:18944
  s_waitcnt lgkmcnt(6)
  v_mfma_f32_32x32x16_bf16 v[80:95], v[236:239], v[52:55], v[80:95]
  ds_read_b64_tr_b16 v[40:41], v8 offset:18432
  ds_read_b64_tr_b16 v[42:43], v8 offset:18944
  s_waitcnt vmcnt(10)
  s_barrier
  s_waitcnt lgkmcnt(6)
  v_mfma_f32_32x32x16_bf16 v[64:79], v[240:243], v[56:59], v[64:79]
  ds_read_b64_tr_b16 v[48:49], v7 offset:20480
  ds_read_b64_tr_b16 v[50:51], v7 offset:20992
  s_waitcnt lgkmcnt(6)
  v_mfma_f32_32x32x16_bf16 v[80:95], v[240:243], v[60:63], v[80:95]
  ds_read_b64_tr_b16 v[52:53], v8 offset:20480
  ds_read_b64_tr_b16 v[54:55], v8 offset:20992
  s_lshl_b32 s52, s34, 10
  s_add_u32 m0, s52, 0
  s_add_u32 s53, s52, 8192
  buffer_load_dwordx4 v3, s[12:15], s39 offen lds
  s_mov_b32 m0, s53
  s_add_u32 s39, s39, s41
  buffer_load_dwordx4 v4, s[16:19], s40 offen lds
  s_add_u32 s40, s40, s41
  s_add_u32 s54, s39, s41
  s_add_u32 s54, s54, s41
  s_lshl_b32 s52, s34, 10
  s_add_u32 m0, s52, 49152
  s_add_u32 s53, s52, 57344
  buffer_load_dwordx4 v3, s[12:15], s54 offen lds
  s_mov_b32 m0, s53
  s_nop 0
  buffer_load_dwordx4 v4, s[16:19], s54 offen lds
  s_waitcnt lgkmcnt(6)
  v_mfma_f32_32x32x16_bf16 v[64:79], v[244:247], v[36:39], v[64:79]
  ds_read_b64_tr_b16 v[56:57], v7 offset:22528
  ds_read_b64_tr_b16 v[58:59], v7 offset:23040
  s_waitcnt lgkmcnt(6)
  v_mfma_f32_32x32x16_bf16 v[80:95], v[244:247], v[40:43], v[80:95]
  ds_read_b64_tr_b16 v[60:61], v8 offset:22528
  ds_read_b64_tr_b16 v[62:63], v8 offset:23040
  s_waitcnt lgkmcnt(6)
  v_mfma_f32_32x32x16_bf16 v[64:79], v[248:251], v[48:51], v[64:79]
  ds_read_b64_tr_b16 v[36:37], v7 offset:32768
  ds_read_b64_tr_b16 v[38:39], v7 offset:33280
  s_waitcnt lgkmcnt(6)
  v_mfma_f32_32x32x16_bf16 v[80:95], v[248:251], v[52:55], v[80:95]
  ds_read_b64_tr_b16 v[40:41], v7 offset:34816
  ds_read_b64_tr_b16 v[42:43], v7 offset:35328
  s_waitcnt lgkmcnt(6)
  v_mfma_f32_32x32x16_bf16 v[64:79], v[252:255], v[56:59], v[64:79]
  ds_read_b64_tr_b16 v[48:49], v7 offset:36864
  ds_read_b64_tr_b16 v[50:51], v7 offset:37376
  s_waitcnt lgkmcnt(6)
  v_mfma_f32_32x32x16_bf16 v[80:95], v[252:255], v[60:63], v[80:95]
  ds_read_b64_tr_b16 v[52:53], v7 offset:38912
  ds_read_b64_tr_b16 v[54:55], v7 offset:39424
parallel_sum__mha_block__glu_gated_swiglu__prompt_kernel_i1:
  s_cmp_lt_u32 s38, 4
  s_cbranch_scc1 parallel_sum__mha_block__glu_gated_swiglu__prompt_kernel_dq
  s_cmp_lt_u32 s38, 8
  s_cbranch_scc1 parallel_sum__mha_block__glu_gated_swiglu__prompt_kernel_dk
  s_cmp_lt_u32 s38, 12
  s_cbranch_scc1 parallel_sum__mha_block__glu_gated_swiglu__prompt_kernel_dv
  s_branch parallel_sum__mha_block__glu_gated_swiglu__prompt_kernel_dg
parallel_sum__mha_block__glu_gated_swiglu__prompt_kernel_dq:
  s_waitcnt vmcnt(6)
  s_barrier
  s_waitcnt lgkmcnt(6)
  v_mfma_f32_32x32x16_bf16 v[96:111], v[36:39], v[128:131], 0
  ds_read_b64_tr_b16 v[56:57], v7 offset:49152
  ds_read_b64_tr_b16 v[58:59], v7 offset:49664
  s_waitcnt lgkmcnt(6)
  v_mfma_f32_32x32x16_bf16 v[96:111], v[40:43], v[132:135], v[96:111]
  ds_read_b64_tr_b16 v[60:61], v7 offset:51200
  ds_read_b64_tr_b16 v[62:63], v7 offset:51712
  v_mul_f32 v64, 0x3eb8aa3b, v64
  v_mul_f32 v65, 0x3eb8aa3b, v65
  v_mul_f32 v66, 0x3eb8aa3b, v66
  v_mul_f32 v67, 0x3eb8aa3b, v67
  v_mul_f32 v68, 0x3eb8aa3b, v68
  v_mul_f32 v69, 0x3eb8aa3b, v69
  v_mul_f32 v70, 0x3eb8aa3b, v70
  v_mul_f32 v71, 0x3eb8aa3b, v71
  v_mul_f32 v72, 0x3eb8aa3b, v72
  v_mul_f32 v73, 0x3eb8aa3b, v73
  v_mul_f32 v74, 0x3eb8aa3b, v74
  v_mul_f32 v75, 0x3eb8aa3b, v75
  s_waitcnt lgkmcnt(6)
  v_mfma_f32_32x32x16_bf16 v[96:111], v[48:51], v[136:139], v[96:111]
  ds_read_b64_tr_b16 v[36:37], v7 offset:53248
  ds_read_b64_tr_b16 v[38:39], v7 offset:53760
  v_mul_f32 v76, 0x3eb8aa3b, v76
  v_mul_f32 v77, 0x3eb8aa3b, v77
  v_mul_f32 v78, 0x3eb8aa3b, v78
  v_mul_f32 v79, 0x3eb8aa3b, v79
  v_mul_f32 v24, v64, v64
  v_mul_f32 v25, v72, v72
  v_fma_f32 v24, v65, v65, v24
  v_fma_f32 v25, v73, v73, v25
  v_fma_f32 v24, v66, v66, v24
  v_fma_f32 v25, v74, v74, v25
  v_fma_f32 v24, v67, v67, v24
  s_waitcnt lgkmcnt(6)
  v_mfma_f32_32x32x16_bf16 v[96:111], v[52:55], v[140:143], v[96:111]
  ds_read_b64_tr_b16 v[40:41], v7 offset:55296
  ds_read_b64_tr_b16 v[42:43], v7 offset:55808
  v_fma_f32 v25, v75, v75, v25
  v_fma_f32 v24, v68, v68, v24
  v_fma_f32 v25, v76, v76, v25
  v_fma_f32 v24, v69, v69, v24
  v_fma_f32 v25, v77, v77, v25
  v_fma_f32 v24, v70, v70, v24
  v_fma_f32 v25, v78, v78, v25
  v_fma_f32 v24, v71, v71, v24
  v_fma_f32 v25, v79, v79, v25
  v_cvt_pk_bf16_f32 v16, v64, v65
  v_cvt_pk_bf16_f32 v17, v66, v67
  s_waitcnt lgkmcnt(6)
  v_mfma_f32_32x32x16_bf16 v[96:111], v[56:59], v[144:147], v[96:111]
  ds_read_b64_tr_b16 v[48:49], v33 offset:0
  ds_read_b64_tr_b16 v[50:51], v33 offset:512
  v_cvt_pk_bf16_f32 v18, v68, v69
  v_cvt_pk_bf16_f32 v19, v70, v71
  v_cvt_pk_bf16_f32 v20, v72, v73
  v_cvt_pk_bf16_f32 v21, v74, v75
  v_cvt_pk_bf16_f32 v22, v76, v77
  v_cvt_pk_bf16_f32 v23, v78, v79
  s_add_u32 s75, s43, 0
  s_add_u32 s76, s43, 262144
  v_permlane32_swap_b32 v24, v25
  buffer_store_dwordx4 v[16:19], v2, s[20:23], s75 offen sc1
  buffer_store_dwordx4 v[20:23], v2, s[20:23], s76 offen sc1
  s_waitcnt lgkmcnt(6)
  v_mfma_f32_32x32x16_bf16 v[96:111], v[60:63], v[148:151], v[96:111]
  ds_read_b64_tr_b16 v[52:53], v33 offset:2048
  ds_read_b64_tr_b16 v[54:55], v33 offset:2560
  v_add_f32 v24, v24, v25
  s_nop 1
  v_max_f32_dpp v24, v24, v24 quad_perm:[1,0,3,2] row_mask:0xf bank_mask:0xf
  s_nop 1
  v_max_f32_dpp v24, v24, v24 quad_perm:[2,3,0,1] row_mask:0xf bank_mask:0xf
  s_nop 1
  v_max_f32_dpp v24, v24, v24 row_half_mirror row_mask:0xf bank_mask:0xf
  s_nop 1
  v_max_f32_dpp v24, v24, v24 row_mirror row_mask:0xf bank_mask:0xf
  v_mov_b32 v25, v24
  s_nop 1
  s_waitcnt lgkmcnt(6)
  v_mfma_f32_32x32x16_bf16 v[96:111], v[36:39], v[152:155], v[96:111]
  ds_read_b64_tr_b16 v[56:57], v33 offset:4096
  ds_read_b64_tr_b16 v[58:59], v33 offset:4608
  v_permlane16_swap_b32 v24, v25
  s_nop 1
  v_max_f32 v24, v24, v25
  s_add_u32 s75, s60, 17833984
  buffer_store_dword v24, v1, s[20:23], s75 offen sc1
  v_mul_f32 v80, 0x3eb8aa3b, v80
  v_mul_f32 v81, 0x3eb8aa3b, v81
  v_mul_f32 v82, 0x3eb8aa3b, v82
  v_mul_f32 v83, 0x3eb8aa3b, v83
  v_mul_f32 v84, 0x3eb8aa3b, v84
  v_mul_f32 v85, 0x3eb8aa3b, v85
  s_waitcnt lgkmcnt(6)
  v_mfma_f32_32x32x16_bf16 v[96:111], v[40:43], v[156:159], v[96:111]
  ds_read_b64_tr_b16 v[60:61], v33 offset:6144
  ds_read_b64_tr_b16 v[62:63], v33 offset:6656
  v_mul_f32 v86, 0x3eb8aa3b, v86
  v_mul_f32 v87, 0x3eb8aa3b, v87
  v_mul_f32 v88, 0x3eb8aa3b, v88
  v_mul_f32 v89, 0x3eb8aa3b, v89
  v_mul_f32 v90, 0x3eb8aa3b, v90
  v_mul_f32 v91, 0x3eb8aa3b, v91
  v_mul_f32 v92, 0x3eb8aa3b, v92
  v_mul_f32 v93, 0x3eb8aa3b, v93
  v_mul_f32 v94, 0x3eb8aa3b, v94
  v_mul_f32 v95, 0x3eb8aa3b, v95
  v_mul_f32 v24, v80, v80
  s_waitcnt lgkmcnt(6)
  v_mfma_f32_32x32x16_bf16 v[96:111], v[48:51], v[160:163], v[96:111]
  ds_read_b64_tr_b16 v[36:37], v33 offset:16384
  ds_read_b64_tr_b16 v[38:39], v33 offset:16896
  v_mul_f32 v25, v88, v88
  v_fma_f32 v24, v81, v81, v24
  v_fma_f32 v25, v89, v89, v25
  v_fma_f32 v24, v82, v82, v24
  v_fma_f32 v25, v90, v90, v25
  v_fma_f32 v24, v83, v83, v24
  v_fma_f32 v25, v91, v91, v25
  v_fma_f32 v24, v84, v84, v24
  v_fma_f32 v25, v92, v92, v25
  v_fma_f32 v24, v85, v85, v24
  v_fma_f32 v25, v93, v93, v25
  s_waitcnt lgkmcnt(6)
  v_mfma_f32_32x32x16_bf16 v[96:111], v[52:55], v[164:167], v[96:111]
  ds_read_b64_tr_b16 v[40:41], v33 offset:18432
  ds_read_b64_tr_b16 v[42:43], v33 offset:18944
  v_fma_f32 v24, v86, v86, v24
  v_fma_f32 v25, v94, v94, v25
  v_fma_f32 v24, v87, v87, v24
  v_fma_f32 v25, v95, v95, v25
  v_cvt_pk_bf16_f32 v16, v80, v81
  v_cvt_pk_bf16_f32 v17, v82, v83
  v_cvt_pk_bf16_f32 v18, v84, v85
  v_cvt_pk_bf16_f32 v19, v86, v87
  v_cvt_pk_bf16_f32 v20, v88, v89
  v_cvt_pk_bf16_f32 v21, v90, v91
  v_cvt_pk_bf16_f32 v22, v92, v93
  s_waitcnt lgkmcnt(6)
  v_mfma_f32_32x32x16_bf16 v[96:111], v[56:59], v[168:171], v[96:111]
  ds_read_b64_tr_b16 v[48:49], v33 offset:20480
  ds_read_b64_tr_b16 v[50:51], v33 offset:20992
  v_cvt_pk_bf16_f32 v23, v94, v95
  s_add_u32 s75, s43, 65536
  s_add_u32 s76, s43, 327680
  v_permlane32_swap_b32 v24, v25
  buffer_store_dwordx4 v[16:19], v2, s[20:23], s75 offen sc1
  buffer_store_dwordx4 v[20:23], v2, s[20:23], s76 offen sc1
  v_add_f32 v24, v24, v25
  s_nop 1
  v_max_f32_dpp v24, v24, v24 quad_perm:[1,0,3,2] row_mask:0xf bank_mask:0xf
  s_nop 1
  v_max_f32_dpp v24, v24, v24 quad_perm:[2,3,0,1] row_mask:0xf bank_mask:0xf
  s_waitcnt lgkmcnt(6)
  v_mfma_f32_32x32x16_bf16 v[96:111], v[60:63], v[172:175], v[96:111]
  ds_read_b64_tr_b16 v[52:53], v33 offset:22528
  ds_read_b64_tr_b16 v[54:55], v33 offset:23040
  s_nop 1
  v_max_f32_dpp v24, v24, v24 row_half_mirror row_mask:0xf bank_mask:0xf
  s_nop 1
  v_max_f32_dpp v24, v24, v24 row_mirror row_mask:0xf bank_mask:0xf
  v_mov_b32 v25, v24
  s_nop 1
  v_permlane16_swap_b32 v24, v25
  s_nop 1
  v_max_f32 v24, v24, v25
  s_add_u32 s75, s60, 17834240
  buffer_store_dword v24, v1, s[20:23], s75 offen sc1
  s_waitcnt vmcnt(6)
  s_barrier
  s_waitcnt lgkmcnt(6)
  v_mfma_f32_32x32x16_bf16 v[96:111], v[36:39], v[176:179], v[96:111]
  ds_read_b64_tr_b16 v[56:57], v5 offset:0
  ds_read_b64_tr_b16 v[58:59], v5 offset:512
  s_waitcnt lgkmcnt(6)
  v_mfma_f32_32x32x16_bf16 v[96:111], v[40:43], v[180:183], v[96:111]
  ds_read_b64_tr_b16 v[60:61], v5 offset:2048
  ds_read_b64_tr_b16 v[62:63], v5 offset:2560
  s_waitcnt lgkmcnt(6)
  v_mfma_f32_32x32x16_bf16 v[96:111], v[48:51], v[184:187], v[96:111]
  ds_read_b64_tr_b16 v[36:37], v5 offset:4096
  ds_read_b64_tr_b16 v[38:39], v5 offset:4608
  s_waitcnt lgkmcnt(6)
  v_mfma_f32_32x32x16_bf16 v[96:111], v[52:55], v[188:191], v[96:111]
  ds_read_b64_tr_b16 v[40:41], v5 offset:6144
  ds_read_b64_tr_b16 v[42:43], v5 offset:6656
  s_waitcnt lgkmcnt(6)
  v_mfma_f32_32x32x16_bf16 v[96:111], v[56:59], v[192:195], v[96:111]
  ds_read_b64_tr_b16 v[48:49], v5 offset:16384
  ds_read_b64_tr_b16 v[50:51], v5 offset:16896
  s_waitcnt lgkmcnt(6)
  v_mfma_f32_32x32x16_bf16 v[96:111], v[60:63], v[196:199], v[96:111]
  ds_read_b64_tr_b16 v[52:53], v5 offset:18432
  ds_read_b64_tr_b16 v[54:55], v5 offset:18944
  s_waitcnt lgkmcnt(6)
  v_mfma_f32_32x32x16_bf16 v[96:111], v[36:39], v[200:203], v[96:111]
  ds_read_b64_tr_b16 v[56:57], v5 offset:20480
  ds_read_b64_tr_b16 v[58:59], v5 offset:20992
  s_waitcnt lgkmcnt(6)
  v_mfma_f32_32x32x16_bf16 v[96:111], v[40:43], v[204:207], v[96:111]
  ds_read_b64_tr_b16 v[60:61], v5 offset:22528
  ds_read_b64_tr_b16 v[62:63], v5 offset:23040
  s_waitcnt lgkmcnt(6)
  v_mfma_f32_32x32x16_bf16 v[96:111], v[48:51], v[208:211], v[96:111]
  ds_read_b64_tr_b16 v[36:37], v5 offset:32768
  ds_read_b64_tr_b16 v[38:39], v5 offset:33280
  s_waitcnt lgkmcnt(6)
  v_mfma_f32_32x32x16_bf16 v[96:111], v[52:55], v[212:215], v[96:111]
  ds_read_b64_tr_b16 v[40:41], v5 offset:34816
  ds_read_b64_tr_b16 v[42:43], v5 offset:35328
  s_waitcnt lgkmcnt(6)
  v_mfma_f32_32x32x16_bf16 v[96:111], v[56:59], v[216:219], v[96:111]
  ds_read_b64_tr_b16 v[48:49], v5 offset:36864
  ds_read_b64_tr_b16 v[50:51], v5 offset:37376
  s_waitcnt lgkmcnt(6)
  v_mfma_f32_32x32x16_bf16 v[96:111], v[60:63], v[220:223], v[96:111]
  ds_read_b64_tr_b16 v[52:53], v5 offset:38912
  ds_read_b64_tr_b16 v[54:55], v5 offset:39424
  s_waitcnt lgkmcnt(6)
  v_mfma_f32_32x32x16_bf16 v[96:111], v[36:39], v[224:227], v[96:111]
  ds_read_b64_tr_b16 v[56:57], v5 offset:49152
  ds_read_b64_tr_b16 v[58:59], v5 offset:49664
  s_waitcnt lgkmcnt(6)
  v_mfma_f32_32x32x16_bf16 v[96:111], v[40:43], v[228:231], v[96:111]
  ds_read_b64_tr_b16 v[60:61], v5 offset:51200
  ds_read_b64_tr_b16 v[62:63], v5 offset:51712
  s_waitcnt lgkmcnt(6)
  v_mfma_f32_32x32x16_bf16 v[96:111], v[48:51], v[232:235], v[96:111]
  ds_read_b64_tr_b16 v[36:37], v5 offset:53248
  ds_read_b64_tr_b16 v[38:39], v5 offset:53760
  s_waitcnt lgkmcnt(6)
  v_mfma_f32_32x32x16_bf16 v[96:111], v[52:55], v[236:239], v[96:111]
  ds_read_b64_tr_b16 v[40:41], v5 offset:55296
  ds_read_b64_tr_b16 v[42:43], v5 offset:55808
  s_waitcnt lgkmcnt(6)
  v_mfma_f32_32x32x16_bf16 v[96:111], v[56:59], v[240:243], v[96:111]
  ds_read_b64_tr_b16 v[48:49], v8 offset:32768
  ds_read_b64_tr_b16 v[50:51], v8 offset:33280
  s_waitcnt lgkmcnt(6)
  v_mfma_f32_32x32x16_bf16 v[96:111], v[60:63], v[244:247], v[96:111]
  ds_read_b64_tr_b16 v[52:53], v8 offset:34816
  ds_read_b64_tr_b16 v[54:55], v8 offset:35328
  s_waitcnt lgkmcnt(6)
  v_mfma_f32_32x32x16_bf16 v[96:111], v[36:39], v[248:251], v[96:111]
  ds_read_b64_tr_b16 v[56:57], v8 offset:36864
  ds_read_b64_tr_b16 v[58:59], v8 offset:37376
  s_waitcnt lgkmcnt(6)
  v_mfma_f32_32x32x16_bf16 v[96:111], v[40:43], v[252:255], v[96:111]
  ds_read_b64_tr_b16 v[60:61], v8 offset:38912
  ds_read_b64_tr_b16 v[62:63], v8 offset:39424
  s_branch parallel_sum__mha_block__glu_gated_swiglu__prompt_kernel_tail
parallel_sum__mha_block__glu_gated_swiglu__prompt_kernel_dk:
  s_waitcnt vmcnt(6)
  s_barrier
  s_waitcnt lgkmcnt(6)
  v_mfma_f32_32x32x16_bf16 v[96:111], v[36:39], v[128:131], 0
  ds_read_b64_tr_b16 v[56:57], v7 offset:49152
  ds_read_b64_tr_b16 v[58:59], v7 offset:49664
  s_waitcnt lgkmcnt(6)
  v_mfma_f32_32x32x16_bf16 v[96:111], v[40:43], v[132:135], v[96:111]
  ds_read_b64_tr_b16 v[60:61], v7 offset:51200
  ds_read_b64_tr_b16 v[62:63], v7 offset:51712
  v_mul_f32 v24, v64, v64
  v_mul_f32 v25, v72, v72
  v_fma_f32 v24, v65, v65, v24
  v_fma_f32 v25, v73, v73, v25
  v_fma_f32 v24, v66, v66, v24
  v_fma_f32 v25, v74, v74, v25
  v_fma_f32 v24, v67, v67, v24
  v_fma_f32 v25, v75, v75, v25
  v_fma_f32 v24, v68, v68, v24
  s_waitcnt lgkmcnt(6)
  v_mfma_f32_32x32x16_bf16 v[96:111], v[48:51], v[136:139], v[96:111]
  ds_read_b64_tr_b16 v[36:37], v7 offset:53248
  ds_read_b64_tr_b16 v[38:39], v7 offset:53760
  v_fma_f32 v25, v76, v76, v25
  v_fma_f32 v24, v69, v69, v24
  v_fma_f32 v25, v77, v77, v25
  v_fma_f32 v24, v70, v70, v24
  v_fma_f32 v25, v78, v78, v25
  v_fma_f32 v24, v71, v71, v24
  v_fma_f32 v25, v79, v79, v25
  v_cvt_pk_bf16_f32 v16, v64, v65
  v_cvt_pk_bf16_f32 v17, v66, v67
  s_waitcnt lgkmcnt(6)
  v_mfma_f32_32x32x16_bf16 v[96:111], v[52:55], v[140:143], v[96:111]
  ds_read_b64_tr_b16 v[40:41], v7 offset:55296
  ds_read_b64_tr_b16 v[42:43], v7 offset:55808
  v_cvt_pk_bf16_f32 v18, v68, v69
  v_cvt_pk_bf16_f32 v19, v70, v71
  v_cvt_pk_bf16_f32 v20, v72, v73
  v_cvt_pk_bf16_f32 v21, v74, v75
  v_cvt_pk_bf16_f32 v22, v76, v77
  v_cvt_pk_bf16_f32 v23, v78, v79
  s_add_u32 s75, s43, 0
  s_add_u32 s76, s43, 262144
  s_waitcnt lgkmcnt(6)
  v_mfma_f32_32x32x16_bf16 v[96:111], v[56:59], v[144:147], v[96:111]
  ds_read_b64_tr_b16 v[48:49], v33 offset:0
  ds_read_b64_tr_b16 v[50:51], v33 offset:512
  v_permlane32_swap_b32 v24, v25
  buffer_store_dwordx4 v[16:19], v2, s[20:23], s75 offen sc1
  buffer_store_dwordx4 v[20:23], v2, s[20:23], s76 offen sc1
  v_add_f32 v24, v24, v25
  s_nop 1
  v_max_f32_dpp v24, v24, v24 quad_perm:[1,0,3,2] row_mask:0xf bank_mask:0xf
  s_nop 1
  v_max_f32_dpp v24, v24, v24 quad_perm:[2,3,0,1] row_mask:0xf bank_mask:0xf
  s_waitcnt lgkmcnt(6)
  v_mfma_f32_32x32x16_bf16 v[96:111], v[60:63], v[148:151], v[96:111]
  ds_read_b64_tr_b16 v[52:53], v33 offset:2048
  ds_read_b64_tr_b16 v[54:55], v33 offset:2560
  s_nop 1
  v_max_f32_dpp v24, v24, v24 row_half_mirror row_mask:0xf bank_mask:0xf
  s_nop 1
  v_max_f32_dpp v24, v24, v24 row_mirror row_mask:0xf bank_mask:0xf
  v_mov_b32 v25, v24
  s_nop 1
  v_permlane16_swap_b32 v24, v25
  s_nop 1
  s_waitcnt lgkmcnt(6)
  v_mfma_f32_32x32x16_bf16 v[96:111], v[36:39], v[152:155], v[96:111]
  ds_read_b64_tr_b16 v[56:57], v33 offset:4096
  ds_read_b64_tr_b16 v[58:59], v33 offset:4608
  v_max_f32 v24, v24, v25
  s_add_u32 s75, s60, 17825792
  buffer_store_dword v24, v1, s[20:23], s75 offen sc1
  v_mul_f32 v24, v80, v80
  v_mul_f32 v25, v88, v88
  v_fma_f32 v24, v81, v81, v24
  v_fma_f32 v25, v89, v89, v25
  v_fma_f32 v24, v82, v82, v24
  s_waitcnt lgkmcnt(6)
  v_mfma_f32_32x32x16_bf16 v[96:111], v[40:43], v[156:159], v[96:111]
  ds_read_b64_tr_b16 v[60:61], v33 offset:6144
  ds_read_b64_tr_b16 v[62:63], v33 offset:6656
  v_fma_f32 v25, v90, v90, v25
  v_fma_f32 v24, v83, v83, v24
  v_fma_f32 v25, v91, v91, v25
  v_fma_f32 v24, v84, v84, v24
  v_fma_f32 v25, v92, v92, v25
  v_fma_f32 v24, v85, v85, v24
  v_fma_f32 v25, v93, v93, v25
  v_fma_f32 v24, v86, v86, v24
  s_waitcnt lgkmcnt(6)
  v_mfma_f32_32x32x16_bf16 v[96:111], v[48:51], v[160:163], v[96:111]
  ds_read_b64_tr_b16 v[36:37], v33 offset:16384
  ds_read_b64_tr_b16 v[38:39], v33 offset:16896
  v_fma_f32 v25, v94, v94, v25
  v_fma_f32 v24, v87, v87, v24
  v_fma_f32 v25, v95, v95, v25
  v_cvt_pk_bf16_f32 v16, v80, v81
  v_cvt_pk_bf16_f32 v17, v82, v83
  v_cvt_pk_bf16_f32 v18, v84, v85
  v_cvt_pk_bf16_f32 v19, v86, v87
  v_cvt_pk_bf16_f32 v20, v88, v89
  s_waitcnt lgkmcnt(6)
  v_mfma_f32_32x32x16_bf16 v[96:111], v[52:55], v[164:167], v[96:111]
  ds_read_b64_tr_b16 v[40:41], v33 offset:18432
  ds_read_b64_tr_b16 v[42:43], v33 offset:18944
  v_cvt_pk_bf16_f32 v21, v90, v91
  v_cvt_pk_bf16_f32 v22, v92, v93
  v_cvt_pk_bf16_f32 v23, v94, v95
  s_add_u32 s75, s43, 65536
  s_add_u32 s76, s43, 327680
  v_permlane32_swap_b32 v24, v25
  buffer_store_dwordx4 v[16:19], v2, s[20:23], s75 offen sc1
  buffer_store_dwordx4 v[20:23], v2, s[20:23], s76 offen sc1
  s_waitcnt lgkmcnt(6)
  v_mfma_f32_32x32x16_bf16 v[96:111], v[56:59], v[168:171], v[96:111]
  ds_read_b64_tr_b16 v[48:49], v33 offset:20480
  ds_read_b64_tr_b16 v[50:51], v33 offset:20992
  v_add_f32 v24, v24, v25
  s_nop 1
  v_max_f32_dpp v24, v24, v24 quad_perm:[1,0,3,2] row_mask:0xf bank_mask:0xf
  s_nop 1
  v_max_f32_dpp v24, v24, v24 quad_perm:[2,3,0,1] row_mask:0xf bank_mask:0xf
  s_nop 1
  v_max_f32_dpp v24, v24, v24 row_half_mirror row_mask:0xf bank_mask:0xf
  s_nop 1
  s_waitcnt lgkmcnt(6)
  v_mfma_f32_32x32x16_bf16 v[96:111], v[60:63], v[172:175], v[96:111]
  ds_read_b64_tr_b16 v[52:53], v33 offset:22528
  ds_read_b64_tr_b16 v[54:55], v33 offset:23040
  v_max_f32_dpp v24, v24, v24 row_mirror row_mask:0xf bank_mask:0xf
  v_mov_b32 v25, v24
  s_nop 1
  v_permlane16_swap_b32 v24, v25
  s_nop 1
  v_max_f32 v24, v24, v25
  s_add_u32 s75, s60, 17826048
  buffer_store_dword v24, v1, s[20:23], s75 offen sc1
  s_waitcnt vmcnt(6)
  s_barrier
  s_waitcnt lgkmcnt(6)
  v_mfma_f32_32x32x16_bf16 v[96:111], v[36:39], v[176:179], v[96:111]
  ds_read_b64_tr_b16 v[56:57], v5 offset:0
  ds_read_b64_tr_b16 v[58:59], v5 offset:512
  s_waitcnt lgkmcnt(6)
  v_mfma_f32_32x32x16_bf16 v[96:111], v[40:43], v[180:183], v[96:111]
  ds_read_b64_tr_b16 v[60:61], v5 offset:2048
  ds_read_b64_tr_b16 v[62:63], v5 offset:2560
  s_waitcnt lgkmcnt(6)
  v_mfma_f32_32x32x16_bf16 v[96:111], v[48:51], v[184:187], v[96:111]
  ds_read_b64_tr_b16 v[36:37], v5 offset:4096
  ds_read_b64_tr_b16 v[38:39], v5 offset:4608
  s_waitcnt lgkmcnt(6)
  v_mfma_f32_32x32x16_bf16 v[96:111], v[52:55], v[188:191], v[96:111]
  ds_read_b64_tr_b16 v[40:41], v5 offset:6144
  ds_read_b64_tr_b16 v[42:43], v5 offset:6656
  s_waitcnt lgkmcnt(6)
  v_mfma_f32_32x32x16_bf16 v[96:111], v[56:59], v[192:195], v[96:111]
  ds_read_b64_tr_b16 v[48:49], v5 offset:16384
  ds_read_b64_tr_b16 v[50:51], v5 offset:16896
  s_waitcnt lgkmcnt(6)
  v_mfma_f32_32x32x16_bf16 v[96:111], v[60:63], v[196:199], v[96:111]
  ds_read_b64_tr_b16 v[52:53], v5 offset:18432
  ds_read_b64_tr_b16 v[54:55], v5 offset:18944
  s_waitcnt lgkmcnt(6)
  v_mfma_f32_32x32x16_bf16 v[96:111], v[36:39], v[200:203], v[96:111]
  ds_read_b64_tr_b16 v[56:57], v5 offset:20480
  ds_read_b64_tr_b16 v[58:59], v5 offset:20992
  s_waitcnt lgkmcnt(6)
  v_mfma_f32_32x32x16_bf16 v[96:111], v[40:43], v[204:207], v[96:111]
  ds_read_b64_tr_b16 v[60:61], v5 offset:22528
  ds_read_b64_tr_b16 v[62:63], v5 offset:23040
  s_waitcnt lgkmcnt(6)
  v_mfma_f32_32x32x16_bf16 v[96:111], v[48:51], v[208:211], v[96:111]
  ds_read_b64_tr_b16 v[36:37], v5 offset:32768
  ds_read_b64_tr_b16 v[38:39], v5 offset:33280
  s_waitcnt lgkmcnt(6)
  v_mfma_f32_32x32x16_bf16 v[96:111], v[52:55], v[212:215], v[96:111]
  ds_read_b64_tr_b16 v[40:41], v5 offset:34816
  ds_read_b64_tr_b16 v[42:43], v5 offset:35328
  s_waitcnt lgkmcnt(6)
  v_mfma_f32_32x32x16_bf16 v[96:111], v[56:59], v[216:219], v[96:111]
  ds_read_b64_tr_b16 v[48:49], v5 offset:36864
  ds_read_b64_tr_b16 v[50:51], v5 offset:37376
  s_waitcnt lgkmcnt(6)
  v_mfma_f32_32x32x16_bf16 v[96:111], v[60:63], v[220:223], v[96:111]
  ds_read_b64_tr_b16 v[52:53], v5 offset:38912
  ds_read_b64_tr_b16 v[54:55], v5 offset:39424
  s_waitcnt lgkmcnt(6)
  v_mfma_f32_32x32x16_bf16 v[96:111], v[36:39], v[224:227], v[96:111]
  ds_read_b64_tr_b16 v[56:57], v5 offset:49152
  ds_read_b64_tr_b16 v[58:59], v5 offset:49664
  s_waitcnt lgkmcnt(6)
  v_mfma_f32_32x32x16_bf16 v[96:111], v[40:43], v[228:231], v[96:111]
  ds_read_b64_tr_b16 v[60:61], v5 offset:51200
  ds_read_b64_tr_b16 v[62:63], v5 offset:51712
  s_waitcnt lgkmcnt(6)
  v_mfma_f32_32x32x16_bf16 v[96:111], v[48:51], v[232:235], v[96:111]
  ds_read_b64_tr_b16 v[36:37], v5 offset:53248
  ds_read_b64_tr_b16 v[38:39], v5 offset:53760
  s_waitcnt lgkmcnt(6)
  v_mfma_f32_32x32x16_bf16 v[96:111], v[52:55], v[236:239], v[96:111]
  ds_read_b64_tr_b16 v[40:41], v5 offset:55296
  ds_read_b64_tr_b16 v[42:43], v5 offset:55808
  s_waitcnt lgkmcnt(6)
  v_mfma_f32_32x32x16_bf16 v[96:111], v[56:59], v[240:243], v[96:111]
  ds_read_b64_tr_b16 v[48:49], v8 offset:32768
  ds_read_b64_tr_b16 v[50:51], v8 offset:33280
  s_waitcnt lgkmcnt(6)
  v_mfma_f32_32x32x16_bf16 v[96:111], v[60:63], v[244:247], v[96:111]
  ds_read_b64_tr_b16 v[52:53], v8 offset:34816
  ds_read_b64_tr_b16 v[54:55], v8 offset:35328
  s_waitcnt lgkmcnt(6)
  v_mfma_f32_32x32x16_bf16 v[96:111], v[36:39], v[248:251], v[96:111]
  ds_read_b64_tr_b16 v[56:57], v8 offset:36864
  ds_read_b64_tr_b16 v[58:59], v8 offset:37376
  s_waitcnt lgkmcnt(6)
  v_mfma_f32_32x32x16_bf16 v[96:111], v[40:43], v[252:255], v[96:111]
  ds_read_b64_tr_b16 v[60:61], v8 offset:38912
  ds_read_b64_tr_b16 v[62:63], v8 offset:39424
  s_branch parallel_sum__mha_block__glu_gated_swiglu__prompt_kernel_tail
parallel_sum__mha_block__glu_gated_swiglu__prompt_kernel_dv:
  s_waitcnt vmcnt(6)
  s_barrier
  s_waitcnt lgkmcnt(6)
  v_mfma_f32_32x32x16_bf16 v[96:111], v[36:39], v[128:131], 0
  ds_read_b64_tr_b16 v[56:57], v7 offset:49152
  ds_read_b64_tr_b16 v[58:59], v7 offset:49664
  s_waitcnt lgkmcnt(6)
  v_mfma_f32_32x32x16_bf16 v[96:111], v[40:43], v[132:135], v[96:111]
  ds_read_b64_tr_b16 v[60:61], v7 offset:51200
  ds_read_b64_tr_b16 v[62:63], v7 offset:51712
  v_cvt_pk_bf16_f32 v16, v64, v65
  v_cvt_pk_bf16_f32 v17, v66, v67
  v_cvt_pk_bf16_f32 v18, v68, v69
  s_waitcnt lgkmcnt(6)
  v_mfma_f32_32x32x16_bf16 v[96:111], v[48:51], v[136:139], v[96:111]
  ds_read_b64_tr_b16 v[36:37], v7 offset:53248
  ds_read_b64_tr_b16 v[38:39], v7 offset:53760
  v_cvt_pk_bf16_f32 v19, v70, v71
  v_cvt_pk_bf16_f32 v20, v72, v73
  v_cvt_pk_bf16_f32 v21, v74, v75
  s_waitcnt lgkmcnt(6)
  v_mfma_f32_32x32x16_bf16 v[96:111], v[52:55], v[140:143], v[96:111]
  ds_read_b64_tr_b16 v[40:41], v7 offset:55296
  ds_read_b64_tr_b16 v[42:43], v7 offset:55808
  v_cvt_pk_bf16_f32 v22, v76, v77
  v_cvt_pk_bf16_f32 v23, v78, v79
  s_waitcnt lgkmcnt(6)
  v_mfma_f32_32x32x16_bf16 v[96:111], v[56:59], v[144:147], v[96:111]
  ds_read_b64_tr_b16 v[48:49], v33 offset:0
  ds_read_b64_tr_b16 v[50:51], v33 offset:512
  s_add_u32 s75, s43, 0
  buffer_store_dwordx4 v[16:19], v15, s[20:23], s75 offen sc1
  s_waitcnt lgkmcnt(6)
  v_mfma_f32_32x32x16_bf16 v[96:111], v[60:63], v[148:151], v[96:111]
  ds_read_b64_tr_b16 v[52:53], v33 offset:2048
  ds_read_b64_tr_b16 v[54:55], v33 offset:2560
  buffer_store_dwordx4 v[20:23], v15, s[20:23], s75 offen offset:512 sc1
  s_nop 0
  s_waitcnt lgkmcnt(6)
  v_mfma_f32_32x32x16_bf16 v[96:111], v[36:39], v[152:155], v[96:111]
  ds_read_b64_tr_b16 v[56:57], v33 offset:4096
  ds_read_b64_tr_b16 v[58:59], v33 offset:4608
  v_cvt_pk_bf16_f32 v16, v80, v81
  v_cvt_pk_bf16_f32 v17, v82, v83
  s_waitcnt lgkmcnt(6)
  v_mfma_f32_32x32x16_bf16 v[96:111], v[40:43], v[156:159], v[96:111]
  ds_read_b64_tr_b16 v[60:61], v33 offset:6144
  ds_read_b64_tr_b16 v[62:63], v33 offset:6656
  v_cvt_pk_bf16_f32 v18, v84, v85
  v_cvt_pk_bf16_f32 v19, v86, v87
  s_waitcnt lgkmcnt(6)
  v_mfma_f32_32x32x16_bf16 v[96:111], v[48:51], v[160:163], v[96:111]
  ds_read_b64_tr_b16 v[36:37], v33 offset:16384
  ds_read_b64_tr_b16 v[38:39], v33 offset:16896
  v_cvt_pk_bf16_f32 v20, v88, v89
  v_cvt_pk_bf16_f32 v21, v90, v91
  s_waitcnt lgkmcnt(6)
  v_mfma_f32_32x32x16_bf16 v[96:111], v[52:55], v[164:167], v[96:111]
  ds_read_b64_tr_b16 v[40:41], v33 offset:18432
  ds_read_b64_tr_b16 v[42:43], v33 offset:18944
  v_cvt_pk_bf16_f32 v22, v92, v93
  v_cvt_pk_bf16_f32 v23, v94, v95
  s_waitcnt lgkmcnt(6)
  v_mfma_f32_32x32x16_bf16 v[96:111], v[56:59], v[168:171], v[96:111]
  ds_read_b64_tr_b16 v[48:49], v33 offset:20480
  ds_read_b64_tr_b16 v[50:51], v33 offset:20992
  s_add_u32 s75, s43, 65536
  buffer_store_dwordx4 v[16:19], v15, s[20:23], s75 offen sc1
  s_waitcnt lgkmcnt(6)
  v_mfma_f32_32x32x16_bf16 v[96:111], v[60:63], v[172:175], v[96:111]
  ds_read_b64_tr_b16 v[52:53], v33 offset:22528
  ds_read_b64_tr_b16 v[54:55], v33 offset:23040
  buffer_store_dwordx4 v[20:23], v15, s[20:23], s75 offen offset:512 sc1
  s_nop 0
  s_waitcnt vmcnt(4)
  s_barrier
  s_waitcnt lgkmcnt(6)
  v_mfma_f32_32x32x16_bf16 v[96:111], v[36:39], v[176:179], v[96:111]
  ds_read_b64_tr_b16 v[56:57], v5 offset:0
  ds_read_b64_tr_b16 v[58:59], v5 offset:512
  s_waitcnt lgkmcnt(6)
  v_mfma_f32_32x32x16_bf16 v[96:111], v[40:43], v[180:183], v[96:111]
  ds_read_b64_tr_b16 v[60:61], v5 offset:2048
  ds_read_b64_tr_b16 v[62:63], v5 offset:2560
  s_waitcnt lgkmcnt(6)
  v_mfma_f32_32x32x16_bf16 v[96:111], v[48:51], v[184:187], v[96:111]
  ds_read_b64_tr_b16 v[36:37], v5 offset:4096
  ds_read_b64_tr_b16 v[38:39], v5 offset:4608
  s_waitcnt lgkmcnt(6)
  v_mfma_f32_32x32x16_bf16 v[96:111], v[52:55], v[188:191], v[96:111]
  ds_read_b64_tr_b16 v[40:41], v5 offset:6144
  ds_read_b64_tr_b16 v[42:43], v5 offset:6656
  s_waitcnt lgkmcnt(6)
  v_mfma_f32_32x32x16_bf16 v[96:111], v[56:59], v[192:195], v[96:111]
  ds_read_b64_tr_b16 v[48:49], v5 offset:16384
  ds_read_b64_tr_b16 v[50:51], v5 offset:16896
  s_waitcnt lgkmcnt(6)
  v_mfma_f32_32x32x16_bf16 v[96:111], v[60:63], v[196:199], v[96:111]
  ds_read_b64_tr_b16 v[52:53], v5 offset:18432
  ds_read_b64_tr_b16 v[54:55], v5 offset:18944
  s_waitcnt lgkmcnt(6)
  v_mfma_f32_32x32x16_bf16 v[96:111], v[36:39], v[200:203], v[96:111]
  ds_read_b64_tr_b16 v[56:57], v5 offset:20480
  ds_read_b64_tr_b16 v[58:59], v5 offset:20992
  s_waitcnt lgkmcnt(6)
  v_mfma_f32_32x32x16_bf16 v[96:111], v[40:43], v[204:207], v[96:111]
  ds_read_b64_tr_b16 v[60:61], v5 offset:22528
  ds_read_b64_tr_b16 v[62:63], v5 offset:23040
  s_waitcnt lgkmcnt(6)
  v_mfma_f32_32x32x16_bf16 v[96:111], v[48:51], v[208:211], v[96:111]
  ds_read_b64_tr_b16 v[36:37], v5 offset:32768
  ds_read_b64_tr_b16 v[38:39], v5 offset:33280
  s_waitcnt lgkmcnt(6)
  v_mfma_f32_32x32x16_bf16 v[96:111], v[52:55], v[212:215], v[96:111]
  ds_read_b64_tr_b16 v[40:41], v5 offset:34816
  ds_read_b64_tr_b16 v[42:43], v5 offset:35328
  s_waitcnt lgkmcnt(6)
  v_mfma_f32_32x32x16_bf16 v[96:111], v[56:59], v[216:219], v[96:111]
  ds_read_b64_tr_b16 v[48:49], v5 offset:36864
  ds_read_b64_tr_b16 v[50:51], v5 offset:37376
  s_waitcnt lgkmcnt(6)
  v_mfma_f32_32x32x16_bf16 v[96:111], v[60:63], v[220:223], v[96:111]
  ds_read_b64_tr_b16 v[52:53], v5 offset:38912
  ds_read_b64_tr_b16 v[54:55], v5 offset:39424
  s_waitcnt lgkmcnt(6)
  v_mfma_f32_32x32x16_bf16 v[96:111], v[36:39], v[224:227], v[96:111]
  ds_read_b64_tr_b16 v[56:57], v5 offset:49152
  ds_read_b64_tr_b16 v[58:59], v5 offset:49664
  s_waitcnt lgkmcnt(6)
  v_mfma_f32_32x32x16_bf16 v[96:111], v[40:43], v[228:231], v[96:111]
  ds_read_b64_tr_b16 v[60:61], v5 offset:51200
  ds_read_b64_tr_b16 v[62:63], v5 offset:51712
  s_waitcnt lgkmcnt(6)
  v_mfma_f32_32x32x16_bf16 v[96:111], v[48:51], v[232:235], v[96:111]
  ds_read_b64_tr_b16 v[36:37], v5 offset:53248
  ds_read_b64_tr_b16 v[38:39], v5 offset:53760
  s_waitcnt lgkmcnt(6)
  v_mfma_f32_32x32x16_bf16 v[96:111], v[52:55], v[236:239], v[96:111]
  ds_read_b64_tr_b16 v[40:41], v5 offset:55296
  ds_read_b64_tr_b16 v[42:43], v5 offset:55808
  s_waitcnt lgkmcnt(6)
  v_mfma_f32_32x32x16_bf16 v[96:111], v[56:59], v[240:243], v[96:111]
  ds_read_b64_tr_b16 v[48:49], v8 offset:32768
  ds_read_b64_tr_b16 v[50:51], v8 offset:33280
  s_waitcnt lgkmcnt(6)
  v_mfma_f32_32x32x16_bf16 v[96:111], v[60:63], v[244:247], v[96:111]
  ds_read_b64_tr_b16 v[52:53], v8 offset:34816
  ds_read_b64_tr_b16 v[54:55], v8 offset:35328
  s_waitcnt lgkmcnt(6)
  v_mfma_f32_32x32x16_bf16 v[96:111], v[36:39], v[248:251], v[96:111]
  ds_read_b64_tr_b16 v[56:57], v8 offset:36864
  ds_read_b64_tr_b16 v[58:59], v8 offset:37376
  s_waitcnt lgkmcnt(6)
  v_mfma_f32_32x32x16_bf16 v[96:111], v[40:43], v[252:255], v[96:111]
  ds_read_b64_tr_b16 v[60:61], v8 offset:38912
  ds_read_b64_tr_b16 v[62:63], v8 offset:39424
  s_branch parallel_sum__mha_block__glu_gated_swiglu__prompt_kernel_tail
parallel_sum__mha_block__glu_gated_swiglu__prompt_kernel_dg:
  s_waitcnt vmcnt(6)
  s_barrier
  s_waitcnt lgkmcnt(6)
  v_mfma_f32_32x32x16_bf16 v[96:111], v[36:39], v[128:131], 0
  ds_read_b64_tr_b16 v[56:57], v7 offset:49152
  ds_read_b64_tr_b16 v[58:59], v7 offset:49664
  s_waitcnt lgkmcnt(6)
  v_mfma_f32_32x32x16_bf16 v[96:111], v[40:43], v[132:135], v[96:111]
  ds_read_b64_tr_b16 v[60:61], v7 offset:51200
  ds_read_b64_tr_b16 v[62:63], v7 offset:51712
  v_mul_f32 v16, 0xbfb8aa3b, v64
  v_exp_f32 v16, v16
  v_mul_f32 v72, v64, v72
  v_add_f32 v16, 1.0, v16
  v_rcp_f32 v16, v16
  s_waitcnt lgkmcnt(6)
  v_mfma_f32_32x32x16_bf16 v[96:111], v[48:51], v[136:139], v[96:111]
  ds_read_b64_tr_b16 v[36:37], v7 offset:53248
  ds_read_b64_tr_b16 v[38:39], v7 offset:53760
  s_nop 0
  v_mul_f32 v64, v72, v16
  v_mul_f32 v18, 0xbfb8aa3b, v65
  v_exp_f32 v18, v18
  v_mul_f32 v73, v65, v73
  s_waitcnt lgkmcnt(6)
  v_mfma_f32_32x32x16_bf16 v[96:111], v[52:55], v[140:143], v[96:111]
  ds_read_b64_tr_b16 v[40:41], v7 offset:55296
  ds_read_b64_tr_b16 v[42:43], v7 offset:55808
  v_add_f32 v18, 1.0, v18
  v_rcp_f32 v18, v18
  s_nop 0
  v_mul_f32 v65, v73, v18
  v_cvt_pk_bf16_f32 v24, v64, v65
  s_waitcnt lgkmcnt(6)
  v_mfma_f32_32x32x16_bf16 v[96:111], v[56:59], v[144:147], v[96:111]
  ds_read_b64_tr_b16 v[48:49], v33 offset:0
  ds_read_b64_tr_b16 v[50:51], v33 offset:512
  v_mul_f32 v20, 0xbfb8aa3b, v66
  v_exp_f32 v20, v20
  v_mul_f32 v74, v66, v74
  v_add_f32 v20, 1.0, v20
  v_rcp_f32 v20, v20
  s_waitcnt lgkmcnt(6)
  v_mfma_f32_32x32x16_bf16 v[96:111], v[60:63], v[148:151], v[96:111]
  ds_read_b64_tr_b16 v[52:53], v33 offset:2048
  ds_read_b64_tr_b16 v[54:55], v33 offset:2560
  s_nop 0
  v_mul_f32 v66, v74, v20
  v_mul_f32 v22, 0xbfb8aa3b, v67
  v_exp_f32 v22, v22
  v_mul_f32 v75, v67, v75
  s_waitcnt lgkmcnt(6)
  v_mfma_f32_32x32x16_bf16 v[96:111], v[36:39], v[152:155], v[96:111]
  ds_read_b64_tr_b16 v[56:57], v33 offset:4096
  ds_read_b64_tr_b16 v[58:59], v33 offset:4608
  v_add_f32 v22, 1.0, v22
  v_rcp_f32 v22, v22
  s_nop 0
  v_mul_f32 v67, v75, v22
  v_cvt_pk_bf16_f32 v25, v66, v67
  s_waitcnt lgkmcnt(6)
  v_mfma_f32_32x32x16_bf16 v[96:111], v[40:43], v[156:159], v[96:111]
  ds_read_b64_tr_b16 v[60:61], v33 offset:6144
  ds_read_b64_tr_b16 v[62:63], v33 offset:6656
  v_mul_f32 v16, 0xbfb8aa3b, v68
  v_exp_f32 v16, v16
  v_mul_f32 v76, v68, v76
  v_add_f32 v16, 1.0, v16
  v_rcp_f32 v16, v16
  s_waitcnt lgkmcnt(6)
  v_mfma_f32_32x32x16_bf16 v[96:111], v[48:51], v[160:163], v[96:111]
  ds_read_b64_tr_b16 v[36:37], v33 offset:16384
  ds_read_b64_tr_b16 v[38:39], v33 offset:16896
  s_nop 0
  v_mul_f32 v68, v76, v16
  v_mul_f32 v18, 0xbfb8aa3b, v69
  v_exp_f32 v18, v18
  v_mul_f32 v77, v69, v77
  s_waitcnt lgkmcnt(6)
  v_mfma_f32_32x32x16_bf16 v[96:111], v[52:55], v[164:167], v[96:111]
  ds_read_b64_tr_b16 v[40:41], v33 offset:18432
  ds_read_b64_tr_b16 v[42:43], v33 offset:18944
  v_add_f32 v18, 1.0, v18
  v_rcp_f32 v18, v18
  s_nop 0
  v_mul_f32 v69, v77, v18
  s_waitcnt lgkmcnt(6)
  v_mfma_f32_32x32x16_bf16 v[96:111], v[56:59], v[168:171], v[96:111]
  ds_read_b64_tr_b16 v[48:49], v33 offset:20480
  ds_read_b64_tr_b16 v[50:51], v33 offset:20992
  v_cvt_pk_bf16_f32 v26, v68, v69
  v_mul_f32 v20, 0xbfb8aa3b, v70
  v_exp_f32 v20, v20
  v_mul_f32 v78, v70, v78
  s_waitcnt lgkmcnt(6)
  v_mfma_f32_32x32x16_bf16 v[96:111], v[60:63], v[172:175], v[96:111]
  ds_read_b64_tr_b16 v[52:53], v33 offset:22528
  ds_read_b64_tr_b16 v[54:55], v33 offset:23040
  v_add_f32 v20, 1.0, v20
  v_rcp_f32 v20, v20
  s_nop 0
  v_mul_f32 v70, v78, v20
  s_waitcnt vmcnt(0)
  s_barrier
  s_waitcnt lgkmcnt(6)
  v_mfma_f32_32x32x16_bf16 v[96:111], v[36:39], v[176:179], v[96:111]
  ds_read_b64_tr_b16 v[56:57], v5 offset:0
  ds_read_b64_tr_b16 v[58:59], v5 offset:512
  v_mul_f32 v22, 0xbfb8aa3b, v71
  v_exp_f32 v22, v22
  v_mul_f32 v79, v71, v79
  v_add_f32 v22, 1.0, v22
  s_waitcnt lgkmcnt(6)
  v_mfma_f32_32x32x16_bf16 v[96:111], v[40:43], v[180:183], v[96:111]
  ds_read_b64_tr_b16 v[60:61], v5 offset:2048
  ds_read_b64_tr_b16 v[62:63], v5 offset:2560
  v_rcp_f32 v22, v22
  s_nop 0
  v_mul_f32 v71, v79, v22
  v_cvt_pk_bf16_f32 v27, v70, v71
  s_waitcnt lgkmcnt(6)
  v_mfma_f32_32x32x16_bf16 v[96:111], v[48:51], v[184:187], v[96:111]
  ds_read_b64_tr_b16 v[36:37], v5 offset:4096
  ds_read_b64_tr_b16 v[38:39], v5 offset:4608
  buffer_store_dwordx4 v[24:27], v2, s[20:23], s43 offen offset:0 sc1
  s_nop 0
  v_mul_f32 v16, 0xbfb8aa3b, v80
  v_exp_f32 v16, v16
  s_waitcnt lgkmcnt(6)
  v_mfma_f32_32x32x16_bf16 v[96:111], v[52:55], v[188:191], v[96:111]
  ds_read_b64_tr_b16 v[40:41], v5 offset:6144
  ds_read_b64_tr_b16 v[42:43], v5 offset:6656
  v_mul_f32 v88, v80, v88
  v_add_f32 v16, 1.0, v16
  v_rcp_f32 v16, v16
  s_nop 0
  s_waitcnt lgkmcnt(6)
  v_mfma_f32_32x32x16_bf16 v[96:111], v[56:59], v[192:195], v[96:111]
  ds_read_b64_tr_b16 v[48:49], v5 offset:16384
  ds_read_b64_tr_b16 v[50:51], v5 offset:16896
  v_mul_f32 v80, v88, v16
  v_mul_f32 v18, 0xbfb8aa3b, v81
  v_exp_f32 v18, v18
  v_mul_f32 v89, v81, v89
  s_waitcnt lgkmcnt(6)
  v_mfma_f32_32x32x16_bf16 v[96:111], v[60:63], v[196:199], v[96:111]
  ds_read_b64_tr_b16 v[52:53], v5 offset:18432
  ds_read_b64_tr_b16 v[54:55], v5 offset:18944
  v_add_f32 v18, 1.0, v18
  v_rcp_f32 v18, v18
  s_nop 0
  v_mul_f32 v81, v89, v18
  s_waitcnt lgkmcnt(6)
  v_mfma_f32_32x32x16_bf16 v[96:111], v[36:39], v[200:203], v[96:111]
  ds_read_b64_tr_b16 v[56:57], v5 offset:20480
  ds_read_b64_tr_b16 v[58:59], v5 offset:20992
  v_cvt_pk_bf16_f32 v24, v80, v81
  v_mul_f32 v20, 0xbfb8aa3b, v82
  v_exp_f32 v20, v20
  v_mul_f32 v90, v82, v90
  s_waitcnt lgkmcnt(6)
  v_mfma_f32_32x32x16_bf16 v[96:111], v[40:43], v[204:207], v[96:111]
  ds_read_b64_tr_b16 v[60:61], v5 offset:22528
  ds_read_b64_tr_b16 v[62:63], v5 offset:23040
  v_add_f32 v20, 1.0, v20
  v_rcp_f32 v20, v20
  s_nop 0
  v_mul_f32 v82, v90, v20
  s_waitcnt lgkmcnt(6)
  v_mfma_f32_32x32x16_bf16 v[96:111], v[48:51], v[208:211], v[96:111]
  ds_read_b64_tr_b16 v[36:37], v5 offset:32768
  ds_read_b64_tr_b16 v[38:39], v5 offset:33280
  v_mul_f32 v22, 0xbfb8aa3b, v83
  v_exp_f32 v22, v22
  v_mul_f32 v91, v83, v91
  v_add_f32 v22, 1.0, v22
  s_waitcnt lgkmcnt(6)
  v_mfma_f32_32x32x16_bf16 v[96:111], v[52:55], v[212:215], v[96:111]
  ds_read_b64_tr_b16 v[40:41], v5 offset:34816
  ds_read_b64_tr_b16 v[42:43], v5 offset:35328
  v_rcp_f32 v22, v22
  s_nop 0
  v_mul_f32 v83, v91, v22
  v_cvt_pk_bf16_f32 v25, v82, v83
  s_waitcnt lgkmcnt(6)
  v_mfma_f32_32x32x16_bf16 v[96:111], v[56:59], v[216:219], v[96:111]
  ds_read_b64_tr_b16 v[48:49], v5 offset:36864
  ds_read_b64_tr_b16 v[50:51], v5 offset:37376
  v_mul_f32 v16, 0xbfb8aa3b, v84
  v_exp_f32 v16, v16
  v_mul_f32 v92, v84, v92
  v_add_f32 v16, 1.0, v16
  s_waitcnt lgkmcnt(6)
  v_mfma_f32_32x32x16_bf16 v[96:111], v[60:63], v[220:223], v[96:111]
  ds_read_b64_tr_b16 v[52:53], v5 offset:38912
  ds_read_b64_tr_b16 v[54:55], v5 offset:39424
  v_rcp_f32 v16, v16
  s_nop 0
  v_mul_f32 v84, v92, v16
  v_mul_f32 v18, 0xbfb8aa3b, v85
  s_waitcnt lgkmcnt(6)
  v_mfma_f32_32x32x16_bf16 v[96:111], v[36:39], v[224:227], v[96:111]
  ds_read_b64_tr_b16 v[56:57], v5 offset:49152
  ds_read_b64_tr_b16 v[58:59], v5 offset:49664
  v_exp_f32 v18, v18
  v_mul_f32 v93, v85, v93
  v_add_f32 v18, 1.0, v18
  v_rcp_f32 v18, v18
  s_waitcnt lgkmcnt(6)
  v_mfma_f32_32x32x16_bf16 v[96:111], v[40:43], v[228:231], v[96:111]
  ds_read_b64_tr_b16 v[60:61], v5 offset:51200
  ds_read_b64_tr_b16 v[62:63], v5 offset:51712
  s_nop 0
  v_mul_f32 v85, v93, v18
  v_cvt_pk_bf16_f32 v26, v84, v85
  v_mul_f32 v20, 0xbfb8aa3b, v86
  s_waitcnt lgkmcnt(6)
  v_mfma_f32_32x32x16_bf16 v[96:111], v[48:51], v[232:235], v[96:111]
  ds_read_b64_tr_b16 v[36:37], v5 offset:53248
  ds_read_b64_tr_b16 v[38:39], v5 offset:53760
  v_exp_f32 v20, v20
  v_mul_f32 v94, v86, v94
  v_add_f32 v20, 1.0, v20
  v_rcp_f32 v20, v20
  s_waitcnt lgkmcnt(6)
  v_mfma_f32_32x32x16_bf16 v[96:111], v[52:55], v[236:239], v[96:111]
  ds_read_b64_tr_b16 v[40:41], v5 offset:55296
  ds_read_b64_tr_b16 v[42:43], v5 offset:55808
  s_nop 0
  v_mul_f32 v86, v94, v20
  v_mul_f32 v22, 0xbfb8aa3b, v87
  v_exp_f32 v22, v22
  s_waitcnt lgkmcnt(6)
  v_mfma_f32_32x32x16_bf16 v[96:111], v[56:59], v[240:243], v[96:111]
  ds_read_b64_tr_b16 v[48:49], v8 offset:32768
  ds_read_b64_tr_b16 v[50:51], v8 offset:33280
  v_mul_f32 v95, v87, v95
  v_add_f32 v22, 1.0, v22
  v_rcp_f32 v22, v22
  s_nop 0
  s_waitcnt lgkmcnt(6)
  v_mfma_f32_32x32x16_bf16 v[96:111], v[60:63], v[244:247], v[96:111]
  ds_read_b64_tr_b16 v[52:53], v8 offset:34816
  ds_read_b64_tr_b16 v[54:55], v8 offset:35328
  v_mul_f32 v87, v95, v22
  v_cvt_pk_bf16_f32 v27, v86, v87
  buffer_store_dwordx4 v[24:27], v2, s[20:23], s43 offen offset:1024 sc1
  s_nop 0
  s_waitcnt lgkmcnt(6)
  v_mfma_f32_32x32x16_bf16 v[96:111], v[36:39], v[248:251], v[96:111]
  ds_read_b64_tr_b16 v[56:57], v8 offset:36864
  ds_read_b64_tr_b16 v[58:59], v8 offset:37376
  s_waitcnt lgkmcnt(6)
  v_mfma_f32_32x32x16_bf16 v[96:111], v[40:43], v[252:255], v[96:111]
  ds_read_b64_tr_b16 v[60:61], v8 offset:38912
  ds_read_b64_tr_b16 v[62:63], v8 offset:39424
  s_branch parallel_sum__mha_block__glu_gated_swiglu__prompt_kernel_tail
parallel_sum__mha_block__glu_gated_swiglu__prompt_kernel_tail:
  s_waitcnt lgkmcnt(6)
  v_mfma_f32_32x32x16_bf16 v[112:127], v[48:51], v[128:131], 0
  ds_read_b64_tr_b16 v[36:37], v8 offset:49152
  ds_read_b64_tr_b16 v[38:39], v8 offset:49664
  s_waitcnt lgkmcnt(6)
  v_mfma_f32_32x32x16_bf16 v[112:127], v[52:55], v[132:135], v[112:127]
  ds_read_b64_tr_b16 v[40:41], v8 offset:51200
  ds_read_b64_tr_b16 v[42:43], v8 offset:51712
  s_waitcnt lgkmcnt(6)
  v_mfma_f32_32x32x16_bf16 v[112:127], v[56:59], v[136:139], v[112:127]
  ds_read_b64_tr_b16 v[48:49], v8 offset:53248
  ds_read_b64_tr_b16 v[50:51], v8 offset:53760
  v_mul_f32 v16, 0xbfb8aa3b, v96
  v_exp_f32 v16, v16
  v_mul_f32 v104, v96, v104
  s_waitcnt lgkmcnt(6)
  v_mfma_f32_32x32x16_bf16 v[112:127], v[60:63], v[140:143], v[112:127]
  ds_read_b64_tr_b16 v[52:53], v8 offset:55296
  ds_read_b64_tr_b16 v[54:55], v8 offset:55808
  v_add_f32 v16, 1.0, v16
  v_rcp_f32 v16, v16
  s_nop 0
  s_waitcnt lgkmcnt(6)
  v_mfma_f32_32x32x16_bf16 v[112:127], v[36:39], v[144:147], v[112:127]
  ds_read_b64_tr_b16 v[56:57], v34 offset:0
  ds_read_b64_tr_b16 v[58:59], v34 offset:512
  v_mul_f32 v96, v104, v16
  v_mul_f32 v18, 0xbfb8aa3b, v97
  v_exp_f32 v18, v18
  s_waitcnt lgkmcnt(6)
  v_mfma_f32_32x32x16_bf16 v[112:127], v[40:43], v[148:151], v[112:127]
  ds_read_b64_tr_b16 v[60:61], v34 offset:2048
  ds_read_b64_tr_b16 v[62:63], v34 offset:2560
  v_mul_f32 v105, v97, v105
  v_add_f32 v18, 1.0, v18
  v_rcp_f32 v18, v18
  s_waitcnt lgkmcnt(6)
  v_mfma_f32_32x32x16_bf16 v[112:127], v[48:51], v[152:155], v[112:127]
  ds_read_b64_tr_b16 v[36:37], v34 offset:4096
  ds_read_b64_tr_b16 v[38:39], v34 offset:4608
  s_nop 0
  v_mul_f32 v97, v105, v18
  v_cvt_pk_bf16_f32 v24, v96, v97
  s_waitcnt lgkmcnt(6)
  v_mfma_f32_32x32x16_bf16 v[112:127], v[52:55], v[156:159], v[112:127]
  ds_read_b64_tr_b16 v[40:41], v34 offset:6144
  ds_read_b64_tr_b16 v[42:43], v34 offset:6656
  v_mul_f32 v20, 0xbfb8aa3b, v98
  v_exp_f32 v20, v20
  v_mul_f32 v106, v98, v106
  s_cmp_eq_u32 s59, 0
  s_cbranch_scc0 parallel_sum__mha_block__glu_gated_swiglu__prompt_kernel_pl0_11
  v_and_b32 v28, 3, v0
  v_lshlrev_b32 v28, 2, v28
  s_lshl_b32 s78, s38, 4
  s_add_u32 s78, s78, 24654848
  v_add_u32 v28, s78, v28
  s_mov_b32 s77, 100000
parallel_sum__mha_block__glu_gated_swiglu__prompt_kernel_p0_12:
  buffer_load_dword v29, v28, s[20:23], 0 offen sc1
  s_waitcnt vmcnt(0)
  v_cmp_ne_u32 vcc, s74, v29
  s_cmp_eq_u64 vcc, 0
  s_cbranch_scc1 parallel_sum__mha_block__glu_gated_swiglu__prompt_kernel_p0_12_ok
  s_sleep 2
  s_sub_u32 s77, s77, 1
  s_cmp_lg_u32 s77, 0
  s_cbranch_scc1 parallel_sum__mha_block__glu_gated_swiglu__prompt_kernel_p0_12
parallel_sum__mha_block__glu_gated_swiglu__prompt_kernel_p0_12_ok:
parallel_sum__mha_block__glu_gated_swiglu__prompt_kernel_pl0_11:
  s_waitcnt vmcnt(0)
  s_barrier
  s_cmp_lt_u32 s38, 12
  s_cbranch_scc0 parallel_sum__mha_block__glu_gated_swiglu__prompt_kernel_sg1_13
  s_cmp_eq_u32 s34, 0
  s_cbranch_scc0 parallel_sum__mha_block__glu_gated_swiglu__prompt_kernel_sg1_13
  s_lshl_b32 s77, s38, 6
  s_lshl_b32 s78, s37, 2
  s_add_u32 s77, s77, s78
  s_add_u32 s77, s77, 24641536
  v_mov_b32 v94, s74
  v_mov_b32 v95, 0
  buffer_store_dword v94, v95, s[20:23], s77 offen sc1
parallel_sum__mha_block__glu_gated_swiglu__prompt_kernel_sg1_13:
  s_cmp_lt_u32 s38, 6
  s_cbranch_scc0 parallel_sum__mha_block__glu_gated_swiglu__prompt_kernel_s1w_14
  s_lshl_b32 s54, s38, 15
  s_lshl_b32 s52, s34, 10
  s_add_u32 s54, s54, s52
  s_add_u32 s54, s54, 18087936
  s_add_u32 m0, s52, 98304
  s_add_u32 s55, s54, 0
  buffer_load_dwordx4 v2, s[20:23], s55 offen sc1 lds
  s_add_u32 m0, s52, 106496
  s_add_u32 s55, s54, 8192
  buffer_load_dwordx4 v2, s[20:23], s55 offen sc1 lds
  s_add_u32 m0, s52, 114688
  s_add_u32 s55, s54, 16384
  buffer_load_dwordx4 v2, s[20:23], s55 offen sc1 lds
  s_add_u32 m0, s52, 122880
  s_add_u32 s55, s54, 24576
  buffer_load_dwordx4 v2, s[20:23], s55 offen sc1 lds
parallel_sum__mha_block__glu_gated_swiglu__prompt_kernel_s1w_14:
  v_add_u32 v9, 98304, v2
  s_waitcnt lgkmcnt(6)
  v_mfma_f32_32x32x16_bf16 v[112:127], v[56:59], v[160:163], v[112:127]
  ds_read_b64_tr_b16 v[48:49], v34 offset:16384
  ds_read_b64_tr_b16 v[50:51], v34 offset:16896
  v_add_f32 v20, 1.0, v20
  v_rcp_f32 v20, v20
  s_waitcnt lgkmcnt(6)
  v_mfma_f32_32x32x16_bf16 v[112:127], v[60:63], v[164:167], v[112:127]
  ds_read_b64_tr_b16 v[52:53], v34 offset:18432
  ds_read_b64_tr_b16 v[54:55], v34 offset:18944
  s_nop 0
  v_mul_f32 v98, v106, v20
  s_waitcnt lgkmcnt(6)
  v_mfma_f32_32x32x16_bf16 v[112:127], v[36:39], v[168:171], v[112:127]
  ds_read_b64_tr_b16 v[56:57], v34 offset:20480
  ds_read_b64_tr_b16 v[58:59], v34 offset:20992
  v_mul_f32 v22, 0xbfb8aa3b, v99
  v_exp_f32 v22, v22
  s_waitcnt lgkmcnt(6)
  v_mfma_f32_32x32x16_bf16 v[112:127], v[40:43], v[172:175], v[112:127]
  ds_read_b64_tr_b16 v[60:61], v34 offset:22528
  ds_read_b64_tr_b16 v[62:63], v34 offset:23040
  v_mul_f32 v107, v99, v107
  v_add_f32 v22, 1.0, v22
  s_waitcnt lgkmcnt(6)
  v_mfma_f32_32x32x16_bf16 v[112:127], v[48:51], v[176:179], v[112:127]
  ds_read_b64_tr_b16 v[36:37], v6 offset:0
  ds_read_b64_tr_b16 v[38:39], v6 offset:512
  v_rcp_f32 v22, v22
  s_nop 0
  s_waitcnt lgkmcnt(6)
  v_mfma_f32_32x32x16_bf16 v[112:127], v[52:55], v[180:183], v[112:127]
  ds_read_b64_tr_b16 v[40:41], v6 offset:2048
  ds_read_b64_tr_b16 v[42:43], v6 offset:2560
  v_mul_f32 v99, v107, v22
  v_cvt_pk_bf16_f32 v25, v98, v99
  s_waitcnt lgkmcnt(6)
  v_mfma_f32_32x32x16_bf16 v[112:127], v[56:59], v[184:187], v[112:127]
  ds_read_b64_tr_b16 v[48:49], v6 offset:4096
  ds_read_b64_tr_b16 v[50:51], v6 offset:4608
  v_mul_f32 v16, 0xbfb8aa3b, v100
  v_exp_f32 v16, v16
  s_waitcnt lgkmcnt(6)
  v_mfma_f32_32x32x16_bf16 v[112:127], v[60:63], v[188:191], v[112:127]
  ds_read_b64_tr_b16 v[52:53], v6 offset:6144
  ds_read_b64_tr_b16 v[54:55], v6 offset:6656
  v_mul_f32 v108, v100, v108
  v_add_f32 v16, 1.0, v16
  s_waitcnt lgkmcnt(6)
  v_mfma_f32_32x32x16_bf16 v[112:127], v[36:39], v[192:195], v[112:127]
  ds_read_b64_tr_b16 v[56:57], v6 offset:16384
  ds_read_b64_tr_b16 v[58:59], v6 offset:16896
  v_rcp_f32 v16, v16
  s_nop 0
  s_waitcnt lgkmcnt(6)
  v_mfma_f32_32x32x16_bf16 v[112:127], v[40:43], v[196:199], v[112:127]
  ds_read_b64_tr_b16 v[60:61], v6 offset:18432
  ds_read_b64_tr_b16 v[62:63], v6 offset:18944
  v_mul_f32 v100, v108, v16
  v_mul_f32 v18, 0xbfb8aa3b, v101
  s_waitcnt lgkmcnt(6)
  v_mfma_f32_32x32x16_bf16 v[112:127], v[48:51], v[200:203], v[112:127]
  ds_read_b64_tr_b16 v[36:37], v6 offset:20480
  ds_read_b64_tr_b16 v[38:39], v6 offset:20992
  v_exp_f32 v18, v18
  v_mul_f32 v109, v101, v109
  s_waitcnt lgkmcnt(6)
  v_mfma_f32_32x32x16_bf16 v[112:127], v[52:55], v[204:207], v[112:127]
  ds_read_b64_tr_b16 v[40:41], v6 offset:22528
  ds_read_b64_tr_b16 v[42:43], v6 offset:23040
  v_add_f32 v18, 1.0, v18
  v_rcp_f32 v18, v18
  s_waitcnt lgkmcnt(6)
  v_mfma_f32_32x32x16_bf16 v[112:127], v[56:59], v[208:211], v[112:127]
  ds_read_b64_tr_b16 v[48:49], v6 offset:32768
  ds_read_b64_tr_b16 v[50:51], v6 offset:33280
  s_nop 0
  v_mul_f32 v101, v109, v18
  s_waitcnt lgkmcnt(6)
  v_mfma_f32_32x32x16_bf16 v[112:127], v[60:63], v[212:215], v[112:127]
  ds_read_b64_tr_b16 v[52:53], v6 offset:34816
  ds_read_b64_tr_b16 v[54:55], v6 offset:35328
  v_cvt_pk_bf16_f32 v26, v100, v101
  v_mul_f32 v20, 0xbfb8aa3b, v102
  s_waitcnt lgkmcnt(6)
  v_mfma_f32_32x32x16_bf16 v[112:127], v[36:39], v[216:219], v[112:127]
  ds_read_b64_tr_b16 v[56:57], v6 offset:36864
  ds_read_b64_tr_b16 v[58:59], v6 offset:37376
  v_exp_f32 v20, v20
  v_mul_f32 v110, v102, v110
  s_waitcnt lgkmcnt(6)
  v_mfma_f32_32x32x16_bf16 v[112:127], v[40:43], v[220:223], v[112:127]
  ds_read_b64_tr_b16 v[60:61], v6 offset:38912
  ds_read_b64_tr_b16 v[62:63], v6 offset:39424
  v_add_f32 v20, 1.0, v20
  v_rcp_f32 v20, v20
  s_waitcnt lgkmcnt(6)
  v_mfma_f32_32x32x16_bf16 v[112:127], v[48:51], v[224:227], v[112:127]
  ds_read_b64_tr_b16 v[36:37], v6 offset:49152
  ds_read_b64_tr_b16 v[38:39], v6 offset:49664
  s_nop 0
  v_mul_f32 v102, v110, v20
  s_waitcnt lgkmcnt(6)
  v_mfma_f32_32x32x16_bf16 v[112:127], v[52:55], v[228:231], v[112:127]
  ds_read_b64_tr_b16 v[40:41], v6 offset:51200
  ds_read_b64_tr_b16 v[42:43], v6 offset:51712
  v_mul_f32 v22, 0xbfb8aa3b, v103
  v_exp_f32 v22, v22
  s_waitcnt vmcnt(0)
  s_barrier
  s_waitcnt lgkmcnt(6)
  v_mfma_f32_32x32x16_bf16 v[112:127], v[56:59], v[232:235], v[112:127]
  ds_read_b64_tr_b16 v[48:49], v6 offset:53248
  ds_read_b64_tr_b16 v[50:51], v6 offset:53760
  v_mul_f32 v111, v103, v111
  v_add_f32 v22, 1.0, v22
  s_waitcnt lgkmcnt(6)
  v_mfma_f32_32x32x16_bf16 v[112:127], v[60:63], v[236:239], v[112:127]
  ds_read_b64_tr_b16 v[52:53], v6 offset:55296
  ds_read_b64_tr_b16 v[54:55], v6 offset:55808
  v_rcp_f32 v22, v22
  s_nop 0
  s_waitcnt lgkmcnt(6)
  v_mfma_f32_32x32x16_bf16 v[112:127], v[36:39], v[240:243], v[112:127]
  ds_read_b128 v[56:59], v9 offset:0
  v_mul_f32 v103, v111, v22
  v_cvt_pk_bf16_f32 v27, v102, v103
  s_waitcnt lgkmcnt(5)
  v_mfma_f32_32x32x16_bf16 v[112:127], v[40:43], v[244:247], v[112:127]
  ds_read_b128 v[60:63], v9 offset:1024
  buffer_store_dwordx4 v[24:27], v2, s[20:23], s44 offen offset:0 sc1
  s_nop 0
  s_waitcnt lgkmcnt(4)
  v_mfma_f32_32x32x16_bf16 v[112:127], v[48:51], v[248:251], v[112:127]
  ds_read_b128 v[36:39], v9 offset:2048
  s_waitcnt lgkmcnt(3)
  v_mfma_f32_32x32x16_bf16 v[112:127], v[52:55], v[252:255], v[112:127]
  ds_read_b128 v[40:43], v9 offset:3072
  s_barrier
  s_cmp_lt_u32 s38, 6
  s_cbranch_scc0 parallel_sum__mha_block__glu_gated_swiglu__prompt_kernel_s1c1
  s_cmp_eq_u32 s36, 0
  s_cbranch_scc1 parallel_sum__mha_block__glu_gated_swiglu__prompt_kernel_s1
parallel_sum__mha_block__glu_gated_swiglu__prompt_kernel_s1c1:
  s_nop 15
  v_mul_f32 v16, 0xbfb8aa3b, v112
  v_exp_f32 v16, v16
  v_mul_f32 v120, v112, v120
  v_add_f32 v16, 1.0, v16
  v_rcp_f32 v16, v16
  s_nop 0
  v_mul_f32 v112, v120, v16
  v_mul_f32 v18, 0xbfb8aa3b, v113
  v_exp_f32 v18, v18
  v_mul_f32 v121, v113, v121
  v_add_f32 v18, 1.0, v18
  v_rcp_f32 v18, v18
  s_nop 0
  v_mul_f32 v113, v121, v18
  v_cvt_pk_bf16_f32 v24, v112, v113
  v_mul_f32 v20, 0xbfb8aa3b, v114
  v_exp_f32 v20, v20
  v_mul_f32 v122, v114, v122
  v_add_f32 v20, 1.0, v20
  v_rcp_f32 v20, v20
  s_nop 0
  v_mul_f32 v114, v122, v20
  v_mul_f32 v22, 0xbfb8aa3b, v115
  v_exp_f32 v22, v22
  v_mul_f32 v123, v115, v123
  v_add_f32 v22, 1.0, v22
  v_rcp_f32 v22, v22
  s_nop 0
  v_mul_f32 v115, v123, v22
  v_cvt_pk_bf16_f32 v25, v114, v115
  v_mul_f32 v16, 0xbfb8aa3b, v116
  v_exp_f32 v16, v16
  v_mul_f32 v124, v116, v124
  v_add_f32 v16, 1.0, v16
  v_rcp_f32 v16, v16
  s_nop 0
  v_mul_f32 v116, v124, v16
  v_mul_f32 v18, 0xbfb8aa3b, v117
  v_exp_f32 v18, v18
  v_mul_f32 v125, v117, v125
  v_add_f32 v18, 1.0, v18
  v_rcp_f32 v18, v18
  s_nop 0
  v_mul_f32 v117, v125, v18
  v_cvt_pk_bf16_f32 v26, v116, v117
  v_mul_f32 v20, 0xbfb8aa3b, v118
  v_exp_f32 v20, v20
  v_mul_f32 v126, v118, v126
  v_add_f32 v20, 1.0, v20
  v_rcp_f32 v20, v20
  s_nop 0
  v_mul_f32 v118, v126, v20
  v_mul_f32 v22, 0xbfb8aa3b, v119
  v_exp_f32 v22, v22
  v_mul_f32 v127, v119, v127
  v_add_f32 v22, 1.0, v22
  v_rcp_f32 v22, v22
  s_nop 0
  v_mul_f32 v119, v127, v22
  v_cvt_pk_bf16_f32 v27, v118, v119
  s_add_u32 s81, s44, 1024
  s_branch parallel_sum__mha_block__glu_gated_swiglu__prompt_kernel_done
parallel_sum__mha_block__glu_gated_swiglu__prompt_kernel_s1:
  s_waitcnt lgkmcnt(3)
  v_mfma_f32_32x32x16_bf16 v[64:79], v[56:59], v[128:131], 0
  ds_read_b128 v[48:51], v9 offset:4096
  s_waitcnt lgkmcnt(3)
  v_mfma_f32_32x32x16_bf16 v[64:79], v[60:63], v[132:135], v[64:79]
  ds_read_b128 v[52:55], v9 offset:5120
  s_waitcnt lgkmcnt(3)
  v_mfma_f32_32x32x16_bf16 v[64:79], v[36:39], v[136:139], v[64:79]
  ds_read_b128 v[56:59], v9 offset:6144
  v_mul_f32 v16, 0xbfb8aa3b, v112
  v_exp_f32 v16, v16
  v_mul_f32 v120, v112, v120
  s_waitcnt lgkmcnt(3)
  v_mfma_f32_32x32x16_bf16 v[64:79], v[40:43], v[140:143], v[64:79]
  ds_read_b128 v[60:63], v9 offset:7168
  v_add_f32 v16, 1.0, v16
  v_rcp_f32 v16, v16
  s_nop 0
  s_waitcnt lgkmcnt(3)
  v_mfma_f32_32x32x16_bf16 v[64:79], v[48:51], v[144:147], v[64:79]
  ds_read_b128 v[36:39], v9 offset:8192
  v_mul_f32 v112, v120, v16
  v_mul_f32 v18, 0xbfb8aa3b, v113
  v_exp_f32 v18, v18
  s_waitcnt lgkmcnt(3)
  v_mfma_f32_32x32x16_bf16 v[64:79], v[52:55], v[148:151], v[64:79]
  ds_read_b128 v[40:43], v9 offset:9216
  v_mul_f32 v121, v113, v121
  v_add_f32 v18, 1.0, v18
  v_rcp_f32 v18, v18
  s_waitcnt lgkmcnt(3)
  v_mfma_f32_32x32x16_bf16 v[64:79], v[56:59], v[152:155], v[64:79]
  ds_read_b128 v[48:51], v9 offset:10240
  s_nop 0
  v_mul_f32 v113, v121, v18
  v_cvt_pk_bf16_f32 v24, v112, v113
  s_waitcnt lgkmcnt(3)
  v_mfma_f32_32x32x16_bf16 v[64:79], v[60:63], v[156:159], v[64:79]
  ds_read_b128 v[52:55], v9 offset:11264
  v_mul_f32 v20, 0xbfb8aa3b, v114
  v_exp_f32 v20, v20
  v_mul_f32 v122, v114, v122
  s_waitcnt lgkmcnt(3)
  v_mfma_f32_32x32x16_bf16 v[64:79], v[36:39], v[160:163], v[64:79]
  ds_read_b128 v[56:59], v9 offset:12288
  v_add_f32 v20, 1.0, v20
  v_rcp_f32 v20, v20
  s_waitcnt lgkmcnt(3)
  v_mfma_f32_32x32x16_bf16 v[64:79], v[40:43], v[164:167], v[64:79]
  ds_read_b128 v[60:63], v9 offset:13312
  s_nop 0
  v_mul_f32 v114, v122, v20
  s_waitcnt lgkmcnt(3)
  v_mfma_f32_32x32x16_bf16 v[64:79], v[48:51], v[168:171], v[64:79]
  ds_read_b128 v[36:39], v9 offset:14336
  v_mul_f32 v22, 0xbfb8aa3b, v115
  v_exp_f32 v22, v22
  s_waitcnt lgkmcnt(3)
  v_mfma_f32_32x32x16_bf16 v[64:79], v[52:55], v[172:175], v[64:79]
  ds_read_b128 v[40:43], v9 offset:15360
  v_mul_f32 v123, v115, v123
  v_add_f32 v22, 1.0, v22
  s_waitcnt lgkmcnt(3)
  v_mfma_f32_32x32x16_bf16 v[64:79], v[56:59], v[176:179], v[64:79]
  ds_read_b128 v[48:51], v9 offset:16384
  v_rcp_f32 v22, v22
  s_nop 0
  s_waitcnt lgkmcnt(3)
  v_mfma_f32_32x32x16_bf16 v[64:79], v[60:63], v[180:183], v[64:79]
  ds_read_b128 v[52:55], v9 offset:17408
  v_mul_f32 v115, v123, v22
  v_cvt_pk_bf16_f32 v25, v114, v115
  s_waitcnt lgkmcnt(3)
  v_mfma_f32_32x32x16_bf16 v[64:79], v[36:39], v[184:187], v[64:79]
  ds_read_b128 v[56:59], v9 offset:18432
  v_mul_f32 v16, 0xbfb8aa3b, v116
  v_exp_f32 v16, v16
  s_waitcnt lgkmcnt(3)
  v_mfma_f32_32x32x16_bf16 v[64:79], v[40:43], v[188:191], v[64:79]
  ds_read_b128 v[60:63], v9 offset:19456
  v_mul_f32 v124, v116, v124
  v_add_f32 v16, 1.0, v16
  s_waitcnt lgkmcnt(3)
  v_mfma_f32_32x32x16_bf16 v[64:79], v[48:51], v[192:195], v[64:79]
  ds_read_b128 v[36:39], v9 offset:20480
  v_rcp_f32 v16, v16
  s_nop 0
  s_waitcnt lgkmcnt(3)
  v_mfma_f32_32x32x16_bf16 v[64:79], v[52:55], v[196:199], v[64:79]
  ds_read_b128 v[40:43], v9 offset:21504
  v_mul_f32 v116, v124, v16
  v_mul_f32 v18, 0xbfb8aa3b, v117
  s_waitcnt lgkmcnt(3)
  v_mfma_f32_32x32x16_bf16 v[64:79], v[56:59], v[200:203], v[64:79]
  ds_read_b128 v[48:51], v9 offset:22528
  v_exp_f32 v18, v18
  v_mul_f32 v125, v117, v125
  s_waitcnt lgkmcnt(3)
  v_mfma_f32_32x32x16_bf16 v[64:79], v[60:63], v[204:207], v[64:79]
  ds_read_b128 v[52:55], v9 offset:23552
  v_add_f32 v18, 1.0, v18
  v_rcp_f32 v18, v18
  s_waitcnt lgkmcnt(3)
  v_mfma_f32_32x32x16_bf16 v[64:79], v[36:39], v[208:211], v[64:79]
  ds_read_b128 v[56:59], v9 offset:24576
  s_nop 0
  v_mul_f32 v117, v125, v18
  s_waitcnt lgkmcnt(3)
  v_mfma_f32_32x32x16_bf16 v[64:79], v[40:43], v[212:215], v[64:79]
  ds_read_b128 v[60:63], v9 offset:25600
  v_cvt_pk_bf16_f32 v26, v116, v117
  v_mul_f32 v20, 0xbfb8aa3b, v118
  s_waitcnt lgkmcnt(3)
  v_mfma_f32_32x32x16_bf16 v[64:79], v[48:51], v[216:219], v[64:79]
  ds_read_b128 v[36:39], v9 offset:26624
  v_exp_f32 v20, v20
  v_mul_f32 v126, v118, v126
  s_waitcnt lgkmcnt(3)
  v_mfma_f32_32x32x16_bf16 v[64:79], v[52:55], v[220:223], v[64:79]
  ds_read_b128 v[40:43], v9 offset:27648
  v_add_f32 v20, 1.0, v20
  v_rcp_f32 v20, v20
  s_waitcnt lgkmcnt(3)
  v_mfma_f32_32x32x16_bf16 v[64:79], v[56:59], v[224:227], v[64:79]
  ds_read_b128 v[48:51], v9 offset:28672
  s_nop 0
  v_mul_f32 v118, v126, v20
  s_waitcnt lgkmcnt(3)
  v_mfma_f32_32x32x16_bf16 v[64:79], v[60:63], v[228:231], v[64:79]
  ds_read_b128 v[52:55], v9 offset:29696
  v_mul_f32 v22, 0xbfb8aa3b, v119
  v_exp_f32 v22, v22
  s_waitcnt lgkmcnt(3)
  v_mfma_f32_32x32x16_bf16 v[64:79], v[36:39], v[232:235], v[64:79]
  ds_read_b128 v[56:59], v9 offset:30720
  v_mul_f32 v127, v119, v127
  v_add_f32 v22, 1.0, v22
  s_waitcnt lgkmcnt(3)
  v_mfma_f32_32x32x16_bf16 v[64:79], v[40:43], v[236:239], v[64:79]
  ds_read_b128 v[60:63], v9 offset:31744
  v_rcp_f32 v22, v22
  s_nop 0
  s_waitcnt lgkmcnt(3)
  v_mfma_f32_32x32x16_bf16 v[64:79], v[48:51], v[240:243], v[64:79]
  v_mul_f32 v119, v127, v22
  v_cvt_pk_bf16_f32 v27, v118, v119
  s_waitcnt lgkmcnt(2)
  v_mfma_f32_32x32x16_bf16 v[64:79], v[52:55], v[244:247], v[64:79]
  buffer_store_dwordx4 v[24:27], v2, s[20:23], s44 offen offset:1024 sc1
  s_nop 0
  s_waitcnt lgkmcnt(1)
  v_mfma_f32_32x32x16_bf16 v[64:79], v[56:59], v[248:251], v[64:79]
  s_waitcnt lgkmcnt(0)
  v_mfma_f32_32x32x16_bf16 v[64:79], v[60:63], v[252:255], v[64:79]
  s_nop 15
  v_mul_f32 v16, 0xbfb8aa3b, v64
  v_exp_f32 v16, v16
  v_mul_f32 v72, v64, v72
  v_add_f32 v16, 1.0, v16
  v_rcp_f32 v16, v16
  s_nop 0
  v_mul_f32 v64, v72, v16
  v_mul_f32 v18, 0xbfb8aa3b, v65
  v_exp_f32 v18, v18
  v_mul_f32 v73, v65, v73
  v_add_f32 v18, 1.0, v18
  v_rcp_f32 v18, v18
  s_nop 0
  v_mul_f32 v65, v73, v18
  v_cvt_pk_bf16_f32 v24, v64, v65
  v_mul_f32 v20, 0xbfb8aa3b, v66
  v_exp_f32 v20, v20
  v_mul_f32 v74, v66, v74
  v_add_f32 v20, 1.0, v20
  v_rcp_f32 v20, v20
  s_nop 0
  v_mul_f32 v66, v74, v20
  v_mul_f32 v22, 0xbfb8aa3b, v67
  v_exp_f32 v22, v22
  v_mul_f32 v75, v67, v75
  v_add_f32 v22, 1.0, v22
  v_rcp_f32 v22, v22
  s_nop 0
  v_mul_f32 v67, v75, v22
  v_cvt_pk_bf16_f32 v25, v66, v67
  v_mul_f32 v16, 0xbfb8aa3b, v68
  v_exp_f32 v16, v16
  v_mul_f32 v76, v68, v76
  v_add_f32 v16, 1.0, v16
  v_rcp_f32 v16, v16
  s_nop 0
  v_mul_f32 v68, v76, v16
  v_mul_f32 v18, 0xbfb8aa3b, v69
  v_exp_f32 v18, v18
  v_mul_f32 v77, v69, v77
  v_add_f32 v18, 1.0, v18
  v_rcp_f32 v18, v18
  s_nop 0
  v_mul_f32 v69, v77, v18
  v_cvt_pk_bf16_f32 v26, v68, v69
  v_mul_f32 v20, 0xbfb8aa3b, v70
  v_exp_f32 v20, v20
  v_mul_f32 v78, v70, v78
  v_add_f32 v20, 1.0, v20
  v_rcp_f32 v20, v20
  s_nop 0
  v_mul_f32 v70, v78, v20
  v_mul_f32 v22, 0xbfb8aa3b, v71
  v_exp_f32 v22, v22
  v_mul_f32 v79, v71, v79
  v_add_f32 v22, 1.0, v22
  v_rcp_f32 v22, v22
  s_nop 0
  v_mul_f32 v71, v79, v22
  v_cvt_pk_bf16_f32 v27, v70, v71
  s_mov_b32 s81, s45
parallel_sum__mha_block__glu_gated_swiglu__prompt_kernel_done:
  s_and_b32 s14, s2, 7
  s_lshr_b32 s15, s2, 3
  s_and_b32 s16, s15, 3
  s_lshl_b32 s17, s14, 2
  s_add_u32 s8, s17, s16
  s_lshr_b32 s9, s15, 2
  s_lshl_b32 s10, s9, 3
  s_add_u32 s10, s10, s34
  s_lshl_b32 s14, s8, 16
  s_lshl_b32 s15, s34, 10
  s_add_u32 s11, s14, s15
  s_add_u32 s12, s11, 4194304
  s_add_u32 s11, s11, 2097152
  s_mov_b32 s13, s15
  s_lshr_b32 s14, s8, 3
  v_and_b32 v94, 63, v0
  v_lshrrev_b32 v95, 4, v94
  v_and_b32 v92, 15, v94
  s_lshl_b32 s15, s9, 1
  v_and_b32 v93, 1, v94
  v_add_u32 v93, s15, v93
  v_cmp_gt_u32 vcc, 2, v95
  v_add_u32 v94, 1, v95
  v_mov_b32 v95, 0
  v_cndmask_b32 v92, v93, v92, vcc
  v_cndmask_b32 v94, v95, v94, vcc
  v_lshlrev_b32 v94, 2, v94
  v_add_u32 v94, s14, v94
  v_lshlrev_b32 v94, 6, v94
  v_lshlrev_b32 v92, 2, v92
  v_add_u32 v94, v94, v92
  v_add_u32 v94, 24641536, v94
  s_cmp_eq_u32 s34, 4
  s_cbranch_scc0 parallel_sum__mha_block__glu_gated_swiglu__prompt_kernel_np_15
  s_mov_b32 s77, 100000
parallel_sum__mha_block__glu_gated_swiglu__prompt_kernel_p1:
  buffer_load_dword v95, v94, s[20:23], 0 offen sc1
  s_waitcnt vmcnt(0)
  v_cmp_ne_u32 vcc, s74, v95
  s_cmp_eq_u64 vcc, 0
  s_cbranch_scc1 parallel_sum__mha_block__glu_gated_swiglu__prompt_kernel_p1_ok
  s_sleep 2
  s_sub_u32 s77, s77, 1
  s_cmp_lg_u32 s77, 0
  s_cbranch_scc1 parallel_sum__mha_block__glu_gated_swiglu__prompt_kernel_p1
parallel_sum__mha_block__glu_gated_swiglu__prompt_kernel_p1_ok:
parallel_sum__mha_block__glu_gated_swiglu__prompt_kernel_np_15:
  s_barrier
  s_lshl_b32 s14, s8, 16
  s_lshl_b32 s15, s10, 10
  s_add_u32 s16, s14, s15
  s_add_u32 s16, s16, 0
  buffer_load_dwordx4 v[88:91], v2, s[20:23], s16 offen sc1
  v_lshrrev_b32 v94, 2, v2
  s_lshl_b32 s17, s8, 8
  s_add_u32 s17, s17, 17825792
  buffer_load_dword v92, v94, s[20:23], s17 offen sc1
  s_add_u32 s17, s17, 8192
  buffer_load_dword v93, v94, s[20:23], s17 offen sc1
  s_add_u32 s16, s13, 0
  s_add_u32 s17, s11, 0
  s_mov_b32 m0, s16
  s_nop 0
  buffer_load_dwordx4 v2, s[20:23], s17 offen sc1 lds
  s_add_u32 s16, s13, 65536
  s_add_u32 s17, s12, 0
  s_mov_b32 m0, s16
  s_nop 0
  buffer_load_dwordx4 v2, s[20:23], s17 offen sc1 lds
  s_add_u32 s16, s13, 8192
  s_add_u32 s17, s11, 8192
  s_mov_b32 m0, s16
  s_nop 0
  buffer_load_dwordx4 v2, s[20:23], s17 offen sc1 lds
  s_add_u32 s16, s13, 73728
  s_add_u32 s17, s12, 8192
  s_mov_b32 m0, s16
  s_nop 0
  buffer_load_dwordx4 v2, s[20:23], s17 offen sc1 lds
  buffer_store_dwordx4 v[24:27], v2, s[20:23], s81 offen sc1
  s_and_b32 s64, s2, 7
  s_lshr_b32 s65, s2, 3
  s_lshl_b32 s60, s64, 3
  s_lshr_b32 s66, s65, 2
  s_add_u32 s60, s60, s66
  s_and_b32 s61, s65, 3
  s_mov_b32 s64, s60
  s_lshl_b32 s65, s61, 2
  s_and_b32 s66, s34, 3
  s_add_u32 s65, s65, s66
  s_mul_i32 s66, s64, 88064
  s_add_u32 s66, s66, 6291456
  s_add_u32 s24, s62, s66
  s_addc_u32 s25, s63, 0
  s_mov_b32 s26, 88064
  s_mov_b32 s27, 0x20000
  s_mul_i32 s66, s65, 88064
  s_add_u32 s66, s66, 14680064
  s_add_u32 s28, s62, s66
  s_addc_u32 s29, s63, 0
  s_mov_b32 s30, 88064
  s_mov_b32 s31, 0x20000
  s_lshl_b32 s33, s65, 15
  s_add_u32 s33, s33, 16777216
  s_mov_b32 s32, 0
  v_and_b32 v6, 63, v0
  v_lshlrev_b32 v10, 4, v0
  v_add_u32 v10, 131072, v10
  v_and_b32 v11, 2, v0
  v_cmp_eq_u32 vcc, 0, v11
  v_mov_b32 v13, 0x3f803f80
  v_mov_b32 v14, 0
  v_cndmask_b32 v12, v14, v13, vcc
  v_mov_b32 v3, v2
  v_mov_b32 v13, v12
  v_mov_b32 v14, v12
  v_mov_b32 v15, v12
  ds_write_b128 v10, v[12:15]
  ds_write_b128 v10, v[12:15] offset:8192
  v_mov_b32 v15, 147456
  v_mov_b32 v14, 0
  ds_write_b32 v15, v14
  v_and_b32 v10, 31, v6
  v_lshrrev_b32 v11, 5, v6
  v_lshlrev_b32 v11, 8, v11
  v_lshlrev_b32 v12, 4, v10
  v_add_u32 v11, v11, v12
  v_add_u32 v11, 65536, v11
  v_subrev_u32 v12, 20, v10
  v_cmp_gt_u32 vcc, 8, v12
  v_mov_b32 v13, 131072
  v_mov_b32 v14, 131136
  v_cndmask_b32 v13, v13, v14, vcc
  v_and_b32 v14, 27, v10
  v_cmp_eq_u32 vcc, 16, v14
  v_add_u32 v14, 32, v13
  s_nop 0
  v_cndmask_b32 v13, v14, v13, vcc
  v_cmp_gt_u32 vcc, 16, v10
  v_mov_b32 v14, 8192
  v_mov_b32 v12, 0
  v_cndmask_b32 v13, v13, v11, vcc
  v_cndmask_b32 v14, v12, v14, vcc
  v_mov_b32 v4, v13
  v_mov_b32 v5, v14
  s_waitcnt vmcnt(5)
  v_mov_b32 v8, v92
  v_mov_b32 v9, v93
  v_lshrrev_b32 v10, 3, v6
  v_cmp_eq_u32 vcc, s9, v10
  v_mov_b32 v15, 0
  v_mov_b32 v12, 0
  v_cndmask_b32 v9, v15, v9, vcc
  v_dot2_f32_bf16 v12, v88, v88, v12
  v_dot2_f32_bf16 v12, v89, v89, v12
  v_dot2_f32_bf16 v12, v90, v90, v12
  v_dot2_f32_bf16 v12, v91, v91, v12
  v_max_f32_dpp v8, v8, v8 quad_perm:[1,0,3,2] row_mask:0xf bank_mask:0xf
  v_max_f32_dpp v9, v9, v9 quad_perm:[1,0,3,2] row_mask:0xf bank_mask:0xf
  s_nop 0
  v_max_f32_dpp v8, v8, v8 quad_perm:[2,3,0,1] row_mask:0xf bank_mask:0xf
  v_max_f32_dpp v9, v9, v9 quad_perm:[2,3,0,1] row_mask:0xf bank_mask:0xf
  s_nop 0
  v_max_f32_dpp v8, v8, v8 row_half_mirror row_mask:0xf bank_mask:0xf
  v_max_f32_dpp v9, v9, v9 row_half_mirror row_mask:0xf bank_mask:0xf
  s_nop 0
  v_max_f32_dpp v8, v8, v8 row_mirror row_mask:0xf bank_mask:0xf
  v_max_f32_dpp v9, v9, v9 row_mirror row_mask:0xf bank_mask:0xf
  s_nop 0
  v_mov_b32 v10, v8
  v_mov_b32 v11, v9
  v_mov_b32 v13, v12
  s_nop 0
  v_permlane16_swap_b32 v8, v10
  v_permlane16_swap_b32 v9, v11
  v_permlane32_swap_b32 v12, v13
  s_nop 0
  v_max_f32 v8, v8, v10
  v_max_f32 v9, v9, v11
  v_add_f32 v12, v12, v13
  v_mov_b32 v10, v8
  v_mov_b32 v11, v9
  s_nop 1
  v_permlane32_swap_b32 v8, v10
  v_permlane32_swap_b32 v9, v11
  s_nop 1
  v_max_f32 v8, v8, v10
  v_max_f32 v9, v9, v11
  v_mul_f32 v12, v12, v8
  v_mul_f32 v9, v9, v8
  v_sqrt_f32 v12, v12
  s_mov_b32 s15, 0x44c80000
  v_cmp_nle_f32 vcc, v9, s15
  v_mul_f32 v10, 0xbf8147ae, v12
  v_mov_b32 v72, v10
  v_mov_b32 v73, v10
  v_mov_b32 v74, v10
  v_mov_b32 v75, v10
  v_mov_b32 v76, v10
  v_mov_b32 v77, v10
  v_mov_b32 v78, v10
  v_mov_b32 v79, v10
  v_mov_b32 v80, v10
  v_mov_b32 v81, v10
  v_mov_b32 v82, v10
  v_mov_b32 v83, v10
  v_mov_b32 v84, v10
  v_mov_b32 v85, v10
  v_mov_b32 v86, v10
  v_mov_b32 v87, v10
  s_cmp_lg_u64 vcc, 0
  s_cbranch_scc0 parallel_sum__mha_block__glu_gated_swiglu__prompt_kernel_fast
  s_barrier
  s_add_u32 s16, s13, 16384
  s_add_u32 s17, s11, 16384
  s_mov_b32 m0, s16
  s_nop 0
  buffer_load_dwordx4 v2, s[20:23], s17 offen sc1 lds
  s_add_u32 s16, s13, 81920
  s_add_u32 s17, s12, 16384
  s_mov_b32 m0, s16
  s_nop 0
  buffer_load_dwordx4 v2, s[20:23], s17 offen sc1 lds
  s_add_u32 s16, s13, 24576
  s_add_u32 s17, s11, 24576
  s_mov_b32 m0, s16
  s_nop 0
  buffer_load_dwordx4 v2, s[20:23], s17 offen sc1 lds
  s_add_u32 s16, s13, 90112
  s_add_u32 s17, s12, 24576
  s_mov_b32 m0, s16
  s_nop 0
  buffer_load_dwordx4 v2, s[20:23], s17 offen sc1 lds
  s_add_u32 s16, s13, 32768
  s_add_u32 s17, s11, 32768
  s_mov_b32 m0, s16
  s_nop 0
  buffer_load_dwordx4 v2, s[20:23], s17 offen sc1 lds
  s_add_u32 s16, s13, 98304
  s_add_u32 s17, s12, 32768
  s_mov_b32 m0, s16
  s_nop 0
  buffer_load_dwordx4 v2, s[20:23], s17 offen sc1 lds
  s_add_u32 s16, s13, 40960
  s_add_u32 s17, s11, 40960
  s_mov_b32 m0, s16
  s_nop 0
  buffer_load_dwordx4 v2, s[20:23], s17 offen sc1 lds
  s_add_u32 s16, s13, 106496
  s_add_u32 s17, s12, 40960
  s_mov_b32 m0, s16
  s_nop 0
  buffer_load_dwordx4 v2, s[20:23], s17 offen sc1 lds
  s_add_u32 s16, s13, 49152
  s_add_u32 s17, s11, 49152
  s_mov_b32 m0, s16
  s_nop 0
  buffer_load_dwordx4 v2, s[20:23], s17 offen sc1 lds
  s_add_u32 s16, s13, 114688
  s_add_u32 s17, s12, 49152
  s_mov_b32 m0, s16
  s_nop 0
  buffer_load_dwordx4 v2, s[20:23], s17 offen sc1 lds
  s_add_u32 s16, s13, 57344
  s_add_u32 s17, s11, 57344
  s_mov_b32 m0, s16
  s_nop 0
  buffer_load_dwordx4 v2, s[20:23], s17 offen sc1 lds
  s_add_u32 s16, s13, 122880
  s_add_u32 s17, s12, 57344
  s_mov_b32 m0, s16
  s_nop 0
  buffer_load_dwordx4 v2, s[20:23], s17 offen sc1 lds
  s_waitcnt vmcnt(0) lgkmcnt(0)
  s_barrier
  v_mov_b32 v10, 0xff800000
  v_mov_b32 v11, v2
  s_mov_b32 s14, 64
parallel_sum__mha_block__glu_gated_swiglu__prompt_kernel_mx:
  ds_read_b128 v[92:95], v11
  v_add_u32 v11, 1024, v11
  s_waitcnt lgkmcnt(0)
  v_mfma_f32_32x32x16_bf16 v[16:31], v[92:95], v[88:91], 0
  s_nop 15
  s_nop 3
  v_max3_f32 v10, v16, v17, v10
  v_max3_f32 v10, v18, v19, v10
  v_max3_f32 v10, v20, v21, v10
  v_max3_f32 v10, v22, v23, v10
  v_max3_f32 v10, v24, v25, v10
  v_max3_f32 v10, v26, v27, v10
  v_max3_f32 v10, v28, v29, v10
  v_max3_f32 v10, v30, v31, v10
  s_sub_u32 s14, s14, 1
  s_cmp_lg_u32 s14, 0
  s_cbranch_scc1 parallel_sum__mha_block__glu_gated_swiglu__prompt_kernel_mx
  v_mov_b32 v11, v10
  s_nop 1
  v_permlane32_swap_b32 v10, v11
  s_nop 1
  v_max_f32 v10, v10, v11
  v_sub_f32 v10, 0, v10
  v_mov_b32 v72, v10
  v_mov_b32 v73, v10
  v_mov_b32 v74, v10
  v_mov_b32 v75, v10
  v_mov_b32 v76, v10
  v_mov_b32 v77, v10
  v_mov_b32 v78, v10
  v_mov_b32 v79, v10
  v_mov_b32 v80, v10
  v_mov_b32 v81, v10
  v_mov_b32 v82, v10
  v_mov_b32 v83, v10
  v_mov_b32 v84, v10
  v_mov_b32 v85, v10
  v_mov_b32 v86, v10
  v_mov_b32 v87, v10
parallel_sum__mha_block__glu_gated_swiglu__prompt_kernel_fast:
  s_waitcnt vmcnt(1) lgkmcnt(0)
  s_barrier
  ds_read_b128 v[92:95], v3 offset:0
  ds_read_b128 v[96:99], v3 offset:1024
  ds_read_b128 v[100:103], v4 offset:0
  s_waitcnt lgkmcnt(2)
  v_mfma_f32_32x32x16_bf16 v[16:31], v[92:95], v[88:91], v[72:87]
  s_waitcnt lgkmcnt(0)
  s_nop 7
  s_cmp_ge_u32 s34, 4
  s_cbranch_scc1 parallel_sum__mha_block__glu_gated_swiglu__prompt_kernel_young
  s_waitcnt lgkmcnt(0)
  v_mfma_f32_32x32x16_bf16 v[32:47], v[96:99], v[88:91], v[72:87]
  ds_read_b128 v[92:95], v3 offset:2048
  v_exp_f32 v16, v16
  v_exp_f32 v17, v17
  v_exp_f32 v18, v18
  v_exp_f32 v19, v19
  v_exp_f32 v20, v20
  s_add_u32 s16, s13, 16384
  s_add_u32 s17, s11, 16384
  s_mov_b32 m0, s16
  s_nop 0
  buffer_load_dwordx4 v2, s[20:23], s17 offen sc1 lds
  s_add_u32 s16, s13, 20480
  s_add_u32 s17, s11, 20480
  s_mov_b32 m0, s16
  s_nop 0
  buffer_load_dwordx4 v2, s[20:23], s17 offen sc1 lds
  s_add_u32 s16, s13, 81920
  s_add_u32 s17, s12, 16384
  s_mov_b32 m0, s16
  s_nop 0
  buffer_load_dwordx4 v2, s[20:23], s17 offen sc1 lds
  s_add_u32 s16, s13, 86016
  s_add_u32 s17, s12, 20480
  s_mov_b32 m0, s16
  s_nop 0
  buffer_load_dwordx4 v2, s[20:23], s17 offen sc1 lds
  ds_read_b128 v[108:111], v4 offset:1024
  v_exp_f32 v21, v21
  v_exp_f32 v22, v22
  v_exp_f32 v23, v23
  v_cvt_pk_bf16_f32 v48, v16, v17
  v_cvt_pk_bf16_f32 v49, v18, v19
  v_cvt_pk_bf16_f32 v50, v20, v21
  v_cvt_pk_bf16_f32 v51, v22, v23
  v_exp_f32 v24, v24
  v_exp_f32 v25, v25
  v_mfma_f32_32x32x16_bf16 v[56:71], v[100:103], v[48:51], 0
  ds_read_b128 v[104:107], v4 offset:512
  v_exp_f32 v26, v26
  v_exp_f32 v27, v27
  v_exp_f32 v28, v28
  v_exp_f32 v29, v29
  v_exp_f32 v30, v30
  v_exp_f32 v31, v31
  v_cvt_pk_bf16_f32 v52, v24, v25
  v_cvt_pk_bf16_f32 v53, v26, v27
  v_cvt_pk_bf16_f32 v54, v28, v29
  v_cvt_pk_bf16_f32 v55, v30, v31
  s_waitcnt lgkmcnt(0)
  v_mfma_f32_32x32x16_bf16 v[16:31], v[92:95], v[88:91], v[72:87]
  ds_read_b128 v[96:99], v3 offset:3072
  v_exp_f32 v32, v32
  v_exp_f32 v33, v33
  v_exp_f32 v34, v34
  v_exp_f32 v35, v35
  v_exp_f32 v36, v36
  s_add_u32 s16, s13, 24576
  s_add_u32 s17, s11, 24576
  s_mov_b32 m0, s16
  s_nop 0
  buffer_load_dwordx4 v2, s[20:23], s17 offen sc1 lds
  s_add_u32 s16, s13, 28672
  s_add_u32 s17, s11, 28672
  s_mov_b32 m0, s16
  s_nop 0
  buffer_load_dwordx4 v2, s[20:23], s17 offen sc1 lds
  s_add_u32 s16, s13, 90112
  s_add_u32 s17, s12, 24576
  s_mov_b32 m0, s16
  s_nop 0
  buffer_load_dwordx4 v2, s[20:23], s17 offen sc1 lds
  s_add_u32 s16, s13, 94208
  s_add_u32 s17, s12, 28672
  s_mov_b32 m0, s16
  s_nop 0
  buffer_load_dwordx4 v2, s[20:23], s17 offen sc1 lds
  v_mfma_f32_32x32x16_bf16 v[56:71], v[104:107], v[52:55], v[56:71]
  ds_read_b128 v[100:103], v4 offset:2048
  v_exp_f32 v37, v37
  v_exp_f32 v38, v38
  v_exp_f32 v39, v39
  v_cvt_pk_bf16_f32 v48, v32, v33
  v_cvt_pk_bf16_f32 v49, v34, v35
  v_cvt_pk_bf16_f32 v50, v36, v37
  v_cvt_pk_bf16_f32 v51, v38, v39
  v_exp_f32 v40, v40
  v_exp_f32 v41, v41
  v_mfma_f32_32x32x16_bf16 v[56:71], v[108:111], v[48:51], v[56:71]
  ds_read_b128 v[112:115], v4 offset:1536
  v_exp_f32 v42, v42
  v_exp_f32 v43, v43
  v_exp_f32 v44, v44
  v_exp_f32 v45, v45
  v_exp_f32 v46, v46
  v_exp_f32 v47, v47
  v_cvt_pk_bf16_f32 v52, v40, v41
  v_cvt_pk_bf16_f32 v53, v42, v43
  v_cvt_pk_bf16_f32 v54, v44, v45
  v_cvt_pk_bf16_f32 v55, v46, v47
  s_waitcnt lgkmcnt(0)
  v_mfma_f32_32x32x16_bf16 v[32:47], v[96:99], v[88:91], v[72:87]
  ds_read_b128 v[92:95], v3 offset:4096
  v_exp_f32 v16, v16
  v_exp_f32 v17, v17
  v_exp_f32 v18, v18
  v_exp_f32 v19, v19
  v_exp_f32 v20, v20
  s_add_u32 s16, s13, 32768
  s_add_u32 s17, s11, 32768
  s_mov_b32 m0, s16
  s_nop 0
  buffer_load_dwordx4 v2, s[20:23], s17 offen sc1 lds
  s_add_u32 s16, s13, 36864
  s_add_u32 s17, s11, 36864
  s_mov_b32 m0, s16
  s_nop 0
  buffer_load_dwordx4 v2, s[20:23], s17 offen sc1 lds
  s_add_u32 s16, s13, 98304
  s_add_u32 s17, s12, 32768
  s_mov_b32 m0, s16
  s_nop 0
  buffer_load_dwordx4 v2, s[20:23], s17 offen sc1 lds
  s_add_u32 s16, s13, 102400
  s_add_u32 s17, s12, 36864
  s_mov_b32 m0, s16
  s_nop 0
  buffer_load_dwordx4 v2, s[20:23], s17 offen sc1 lds
  v_mfma_f32_32x32x16_bf16 v[56:71], v[112:115], v[52:55], v[56:71]
  ds_read_b128 v[108:111], v4 offset:3072
  v_exp_f32 v21, v21
  v_exp_f32 v22, v22
  v_exp_f32 v23, v23
  v_cvt_pk_bf16_f32 v48, v16, v17
  v_cvt_pk_bf16_f32 v49, v18, v19
  v_cvt_pk_bf16_f32 v50, v20, v21
  v_cvt_pk_bf16_f32 v51, v22, v23
  v_exp_f32 v24, v24
  v_exp_f32 v25, v25
  v_mfma_f32_32x32x16_bf16 v[56:71], v[100:103], v[48:51], v[56:71]
  ds_read_b128 v[104:107], v4 offset:2560
  v_exp_f32 v26, v26
  v_exp_f32 v27, v27
  v_exp_f32 v28, v28
  v_exp_f32 v29, v29
  v_exp_f32 v30, v30
  v_exp_f32 v31, v31
  v_cvt_pk_bf16_f32 v52, v24, v25
  v_cvt_pk_bf16_f32 v53, v26, v27
  v_cvt_pk_bf16_f32 v54, v28, v29
  v_cvt_pk_bf16_f32 v55, v30, v31
  s_waitcnt lgkmcnt(0)
  v_mfma_f32_32x32x16_bf16 v[16:31], v[92:95], v[88:91], v[72:87]
  ds_read_b128 v[96:99], v3 offset:5120
  v_exp_f32 v32, v32
  v_exp_f32 v33, v33
  v_exp_f32 v34, v34
  v_exp_f32 v35, v35
  v_exp_f32 v36, v36
  s_add_u32 s16, s13, 40960
  s_add_u32 s17, s11, 40960
  s_mov_b32 m0, s16
  s_nop 0
  buffer_load_dwordx4 v2, s[20:23], s17 offen sc1 lds
  s_add_u32 s16, s13, 45056
  s_add_u32 s17, s11, 45056
  s_mov_b32 m0, s16
  s_nop 0
  buffer_load_dwordx4 v2, s[20:23], s17 offen sc1 lds
  s_add_u32 s16, s13, 106496
  s_add_u32 s17, s12, 40960
  s_mov_b32 m0, s16
  s_nop 0
  buffer_load_dwordx4 v2, s[20:23], s17 offen sc1 lds
  s_add_u32 s16, s13, 110592
  s_add_u32 s17, s12, 45056
  s_mov_b32 m0, s16
  s_nop 0
  buffer_load_dwordx4 v2, s[20:23], s17 offen sc1 lds
  v_mfma_f32_32x32x16_bf16 v[56:71], v[104:107], v[52:55], v[56:71]
  ds_read_b128 v[100:103], v4 offset:4096
  v_exp_f32 v37, v37
  v_exp_f32 v38, v38
  v_exp_f32 v39, v39
  v_cvt_pk_bf16_f32 v48, v32, v33
  v_cvt_pk_bf16_f32 v49, v34, v35
  v_cvt_pk_bf16_f32 v50, v36, v37
  v_cvt_pk_bf16_f32 v51, v38, v39
  v_exp_f32 v40, v40
  v_exp_f32 v41, v41
  v_mfma_f32_32x32x16_bf16 v[56:71], v[108:111], v[48:51], v[56:71]
  ds_read_b128 v[112:115], v4 offset:3584
  v_exp_f32 v42, v42
  v_exp_f32 v43, v43
  v_exp_f32 v44, v44
  v_exp_f32 v45, v45
  v_exp_f32 v46, v46
  v_exp_f32 v47, v47
  v_cvt_pk_bf16_f32 v52, v40, v41
  v_cvt_pk_bf16_f32 v53, v42, v43
  v_cvt_pk_bf16_f32 v54, v44, v45
  v_cvt_pk_bf16_f32 v55, v46, v47
  s_waitcnt lgkmcnt(0)
  v_mfma_f32_32x32x16_bf16 v[32:47], v[96:99], v[88:91], v[72:87]
  ds_read_b128 v[92:95], v3 offset:6144
  v_exp_f32 v16, v16
  v_exp_f32 v17, v17
  v_exp_f32 v18, v18
  v_exp_f32 v19, v19
  v_exp_f32 v20, v20
  s_add_u32 s16, s13, 49152
  s_add_u32 s17, s11, 49152
  s_mov_b32 m0, s16
  s_nop 0
  buffer_load_dwordx4 v2, s[20:23], s17 offen sc1 lds
  s_add_u32 s16, s13, 53248
  s_add_u32 s17, s11, 53248
  s_mov_b32 m0, s16
  s_nop 0
  buffer_load_dwordx4 v2, s[20:23], s17 offen sc1 lds
  s_add_u32 s16, s13, 114688
  s_add_u32 s17, s12, 49152
  s_mov_b32 m0, s16
  s_nop 0
  buffer_load_dwordx4 v2, s[20:23], s17 offen sc1 lds
  s_add_u32 s16, s13, 118784
  s_add_u32 s17, s12, 53248
  s_mov_b32 m0, s16
  s_nop 0
  buffer_load_dwordx4 v2, s[20:23], s17 offen sc1 lds
  v_mfma_f32_32x32x16_bf16 v[56:71], v[112:115], v[52:55], v[56:71]
  ds_read_b128 v[108:111], v4 offset:5120
  v_exp_f32 v21, v21
  v_exp_f32 v22, v22
  v_exp_f32 v23, v23
  v_cvt_pk_bf16_f32 v48, v16, v17
  v_cvt_pk_bf16_f32 v49, v18, v19
  v_cvt_pk_bf16_f32 v50, v20, v21
  v_cvt_pk_bf16_f32 v51, v22, v23
  v_exp_f32 v24, v24
  v_exp_f32 v25, v25
  v_mfma_f32_32x32x16_bf16 v[56:71], v[100:103], v[48:51], v[56:71]
  ds_read_b128 v[104:107], v4 offset:4608
  v_exp_f32 v26, v26
  v_exp_f32 v27, v27
  v_exp_f32 v28, v28
  v_exp_f32 v29, v29
  v_exp_f32 v30, v30
  v_exp_f32 v31, v31
  v_cvt_pk_bf16_f32 v52, v24, v25
  v_cvt_pk_bf16_f32 v53, v26, v27
  v_cvt_pk_bf16_f32 v54, v28, v29
  v_cvt_pk_bf16_f32 v55, v30, v31
  s_waitcnt lgkmcnt(0)
  v_mfma_f32_32x32x16_bf16 v[16:31], v[92:95], v[88:91], v[72:87]
  ds_read_b128 v[96:99], v3 offset:7168
  v_exp_f32 v32, v32
  v_exp_f32 v33, v33
  v_exp_f32 v34, v34
  v_exp_f32 v35, v35
  v_exp_f32 v36, v36
  s_add_u32 s16, s13, 57344
  s_add_u32 s17, s11, 57344
  s_mov_b32 m0, s16
  s_nop 0
  buffer_load_dwordx4 v2, s[20:23], s17 offen sc1 lds
  s_add_u32 s16, s13, 61440
  s_add_u32 s17, s11, 61440
  s_mov_b32 m0, s16
  s_nop 0
  buffer_load_dwordx4 v2, s[20:23], s17 offen sc1 lds
  s_add_u32 s16, s13, 122880
  s_add_u32 s17, s12, 57344
  s_mov_b32 m0, s16
  s_nop 0
  buffer_load_dwordx4 v2, s[20:23], s17 offen sc1 lds
  s_add_u32 s16, s13, 126976
  s_add_u32 s17, s12, 61440
  s_mov_b32 m0, s16
  s_nop 0
  buffer_load_dwordx4 v2, s[20:23], s17 offen sc1 lds
  v_mfma_f32_32x32x16_bf16 v[56:71], v[104:107], v[52:55], v[56:71]
  ds_read_b128 v[100:103], v4 offset:6144
  v_exp_f32 v37, v37
  v_exp_f32 v38, v38
  v_exp_f32 v39, v39
  v_cvt_pk_bf16_f32 v48, v32, v33
  v_cvt_pk_bf16_f32 v49, v34, v35
  v_cvt_pk_bf16_f32 v50, v36, v37
  v_cvt_pk_bf16_f32 v51, v38, v39
  v_exp_f32 v40, v40
  v_exp_f32 v41, v41
  v_mfma_f32_32x32x16_bf16 v[56:71], v[108:111], v[48:51], v[56:71]
  ds_read_b128 v[112:115], v4 offset:5632
  v_exp_f32 v42, v42
  v_exp_f32 v43, v43
  v_exp_f32 v44, v44
  v_exp_f32 v45, v45
  v_exp_f32 v46, v46
  v_exp_f32 v47, v47
  v_cvt_pk_bf16_f32 v52, v40, v41
  v_cvt_pk_bf16_f32 v53, v42, v43
  v_cvt_pk_bf16_f32 v54, v44, v45
  v_cvt_pk_bf16_f32 v55, v46, v47
  s_waitcnt lgkmcnt(0)
  v_mfma_f32_32x32x16_bf16 v[32:47], v[96:99], v[88:91], v[72:87]
  ds_read_b128 v[92:95], v3 offset:8192
  v_exp_f32 v16, v16
  v_exp_f32 v17, v17
  v_exp_f32 v18, v18
  v_exp_f32 v19, v19
  v_exp_f32 v20, v20
  v_mfma_f32_32x32x16_bf16 v[56:71], v[112:115], v[52:55], v[56:71]
  ds_read_b128 v[108:111], v4 offset:7168
  v_exp_f32 v21, v21
  v_exp_f32 v22, v22
  v_exp_f32 v23, v23
  v_cvt_pk_bf16_f32 v48, v16, v17
  v_cvt_pk_bf16_f32 v49, v18, v19
  v_cvt_pk_bf16_f32 v50, v20, v21
  v_cvt_pk_bf16_f32 v51, v22, v23
  v_exp_f32 v24, v24
  v_exp_f32 v25, v25
  v_mfma_f32_32x32x16_bf16 v[56:71], v[100:103], v[48:51], v[56:71]
  ds_read_b128 v[104:107], v4 offset:6656
  v_exp_f32 v26, v26
  v_exp_f32 v27, v27
  v_exp_f32 v28, v28
  v_exp_f32 v29, v29
  v_exp_f32 v30, v30
  v_exp_f32 v31, v31
  v_cvt_pk_bf16_f32 v52, v24, v25
  v_cvt_pk_bf16_f32 v53, v26, v27
  v_cvt_pk_bf16_f32 v54, v28, v29
  v_cvt_pk_bf16_f32 v55, v30, v31
  s_waitcnt lgkmcnt(0)
  v_mfma_f32_32x32x16_bf16 v[16:31], v[92:95], v[88:91], v[72:87]
  ds_read_b128 v[96:99], v3 offset:9216
  v_exp_f32 v32, v32
  v_exp_f32 v33, v33
  v_exp_f32 v34, v34
  v_exp_f32 v35, v35
  v_exp_f32 v36, v36
  v_mfma_f32_32x32x16_bf16 v[56:71], v[104:107], v[52:55], v[56:71]
  ds_read_b128 v[100:103], v4 offset:8192
  v_exp_f32 v37, v37
  v_exp_f32 v38, v38
  v_exp_f32 v39, v39
  v_cvt_pk_bf16_f32 v48, v32, v33
  v_cvt_pk_bf16_f32 v49, v34, v35
  v_cvt_pk_bf16_f32 v50, v36, v37
  v_cvt_pk_bf16_f32 v51, v38, v39
  v_exp_f32 v40, v40
  v_exp_f32 v41, v41
  v_mfma_f32_32x32x16_bf16 v[56:71], v[108:111], v[48:51], v[56:71]
  ds_read_b128 v[112:115], v4 offset:7680
  v_exp_f32 v42, v42
  v_exp_f32 v43, v43
  v_exp_f32 v44, v44
  v_exp_f32 v45, v45
  v_exp_f32 v46, v46
  v_exp_f32 v47, v47
  v_add_u32 v3, 8192, v3
  v_add_u32 v4, v5, v4
  v_cvt_pk_bf16_f32 v52, v40, v41
  v_cvt_pk_bf16_f32 v53, v42, v43
  v_cvt_pk_bf16_f32 v54, v44, v45
  v_cvt_pk_bf16_f32 v55, v46, v47
  s_waitcnt vmcnt(16)
  s_barrier
  s_waitcnt lgkmcnt(0)
  v_mfma_f32_32x32x16_bf16 v[32:47], v[96:99], v[88:91], v[72:87]
  ds_read_b128 v[92:95], v3 offset:2048
  v_exp_f32 v16, v16
  v_exp_f32 v17, v17
  v_exp_f32 v18, v18
  v_exp_f32 v19, v19
  v_exp_f32 v20, v20
  v_mfma_f32_32x32x16_bf16 v[56:71], v[112:115], v[52:55], v[56:71]
  ds_read_b128 v[108:111], v4 offset:1024
  v_exp_f32 v21, v21
  v_exp_f32 v22, v22
  v_exp_f32 v23, v23
  v_cvt_pk_bf16_f32 v48, v16, v17
  v_cvt_pk_bf16_f32 v49, v18, v19
  v_cvt_pk_bf16_f32 v50, v20, v21
  v_cvt_pk_bf16_f32 v51, v22, v23
  v_exp_f32 v24, v24
  v_exp_f32 v25, v25
  v_mfma_f32_32x32x16_bf16 v[56:71], v[100:103], v[48:51], v[56:71]
  ds_read_b128 v[104:107], v4 offset:512
  v_exp_f32 v26, v26
  v_exp_f32 v27, v27
  v_exp_f32 v28, v28
  v_exp_f32 v29, v29
  v_exp_f32 v30, v30
  v_exp_f32 v31, v31
  v_cvt_pk_bf16_f32 v52, v24, v25
  v_cvt_pk_bf16_f32 v53, v26, v27
  v_cvt_pk_bf16_f32 v54, v28, v29
  v_cvt_pk_bf16_f32 v55, v30, v31
  s_waitcnt lgkmcnt(0)
  v_mfma_f32_32x32x16_bf16 v[16:31], v[92:95], v[88:91], v[72:87]
  ds_read_b128 v[96:99], v3 offset:3072
  v_exp_f32 v32, v32
  v_exp_f32 v33, v33
  v_exp_f32 v34, v34
  v_exp_f32 v35, v35
  v_exp_f32 v36, v36
  v_mfma_f32_32x32x16_bf16 v[56:71], v[104:107], v[52:55], v[56:71]
  ds_read_b128 v[100:103], v4 offset:2048
  v_exp_f32 v37, v37
  v_exp_f32 v38, v38
  v_exp_f32 v39, v39
  v_cvt_pk_bf16_f32 v48, v32, v33
  v_cvt_pk_bf16_f32 v49, v34, v35
  v_cvt_pk_bf16_f32 v50, v36, v37
  v_cvt_pk_bf16_f32 v51, v38, v39
  v_exp_f32 v40, v40
  v_exp_f32 v41, v41
  v_mfma_f32_32x32x16_bf16 v[56:71], v[108:111], v[48:51], v[56:71]
  ds_read_b128 v[112:115], v4 offset:1536
  v_exp_f32 v42, v42
  v_exp_f32 v43, v43
  v_exp_f32 v44, v44
  v_exp_f32 v45, v45
  v_exp_f32 v46, v46
  v_exp_f32 v47, v47
  v_cvt_pk_bf16_f32 v52, v40, v41
  v_cvt_pk_bf16_f32 v53, v42, v43
  v_cvt_pk_bf16_f32 v54, v44, v45
  v_cvt_pk_bf16_f32 v55, v46, v47
  s_waitcnt lgkmcnt(0)
  v_mfma_f32_32x32x16_bf16 v[32:47], v[96:99], v[88:91], v[72:87]
  ds_read_b128 v[92:95], v3 offset:4096
  v_exp_f32 v16, v16
  v_exp_f32 v17, v17
  v_exp_f32 v18, v18
  v_exp_f32 v19, v19
  v_exp_f32 v20, v20
  v_mfma_f32_32x32x16_bf16 v[56:71], v[112:115], v[52:55], v[56:71]
  ds_read_b128 v[108:111], v4 offset:3072
  v_exp_f32 v21, v21
  v_exp_f32 v22, v22
  v_exp_f32 v23, v23
  v_cvt_pk_bf16_f32 v48, v16, v17
  v_cvt_pk_bf16_f32 v49, v18, v19
  v_cvt_pk_bf16_f32 v50, v20, v21
  v_cvt_pk_bf16_f32 v51, v22, v23
  v_exp_f32 v24, v24
  v_exp_f32 v25, v25
  v_mfma_f32_32x32x16_bf16 v[56:71], v[100:103], v[48:51], v[56:71]
  ds_read_b128 v[104:107], v4 offset:2560
  v_exp_f32 v26, v26
  v_exp_f32 v27, v27
  v_exp_f32 v28, v28
  v_exp_f32 v29, v29
  v_exp_f32 v30, v30
  v_exp_f32 v31, v31
  v_cvt_pk_bf16_f32 v52, v24, v25
  v_cvt_pk_bf16_f32 v53, v26, v27
  v_cvt_pk_bf16_f32 v54, v28, v29
  v_cvt_pk_bf16_f32 v55, v30, v31
  s_waitcnt lgkmcnt(0)
  v_mfma_f32_32x32x16_bf16 v[16:31], v[92:95], v[88:91], v[72:87]
  ds_read_b128 v[96:99], v3 offset:5120
  v_exp_f32 v32, v32
  v_exp_f32 v33, v33
  v_exp_f32 v34, v34
  v_exp_f32 v35, v35
  v_exp_f32 v36, v36
  v_mfma_f32_32x32x16_bf16 v[56:71], v[104:107], v[52:55], v[56:71]
  ds_read_b128 v[100:103], v4 offset:4096
  v_exp_f32 v37, v37
  v_exp_f32 v38, v38
  v_exp_f32 v39, v39
  v_cvt_pk_bf16_f32 v48, v32, v33
  v_cvt_pk_bf16_f32 v49, v34, v35
  v_cvt_pk_bf16_f32 v50, v36, v37
  v_cvt_pk_bf16_f32 v51, v38, v39
  v_exp_f32 v40, v40
  v_exp_f32 v41, v41
  v_mfma_f32_32x32x16_bf16 v[56:71], v[108:111], v[48:51], v[56:71]
  ds_read_b128 v[112:115], v4 offset:3584
  v_exp_f32 v42, v42
  v_exp_f32 v43, v43
  v_exp_f32 v44, v44
  v_exp_f32 v45, v45
  v_exp_f32 v46, v46
  v_exp_f32 v47, v47
  v_cvt_pk_bf16_f32 v52, v40, v41
  v_cvt_pk_bf16_f32 v53, v42, v43
  v_cvt_pk_bf16_f32 v54, v44, v45
  v_cvt_pk_bf16_f32 v55, v46, v47
  s_waitcnt lgkmcnt(0)
  v_mfma_f32_32x32x16_bf16 v[32:47], v[96:99], v[88:91], v[72:87]
  ds_read_b128 v[92:95], v3 offset:6144
  v_exp_f32 v16, v16
  v_exp_f32 v17, v17
  v_exp_f32 v18, v18
  v_exp_f32 v19, v19
  v_exp_f32 v20, v20
  v_mfma_f32_32x32x16_bf16 v[56:71], v[112:115], v[52:55], v[56:71]
  ds_read_b128 v[108:111], v4 offset:5120
  v_exp_f32 v21, v21
  v_exp_f32 v22, v22
  v_exp_f32 v23, v23
  v_cvt_pk_bf16_f32 v48, v16, v17
  v_cvt_pk_bf16_f32 v49, v18, v19
  v_cvt_pk_bf16_f32 v50, v20, v21
  v_cvt_pk_bf16_f32 v51, v22, v23
  v_exp_f32 v24, v24
  v_exp_f32 v25, v25
  v_mfma_f32_32x32x16_bf16 v[56:71], v[100:103], v[48:51], v[56:71]
  ds_read_b128 v[104:107], v4 offset:4608
  v_exp_f32 v26, v26
  v_exp_f32 v27, v27
  v_exp_f32 v28, v28
  v_exp_f32 v29, v29
  v_exp_f32 v30, v30
  v_exp_f32 v31, v31
  v_cvt_pk_bf16_f32 v52, v24, v25
  v_cvt_pk_bf16_f32 v53, v26, v27
  v_cvt_pk_bf16_f32 v54, v28, v29
  v_cvt_pk_bf16_f32 v55, v30, v31
  s_waitcnt lgkmcnt(0)
  v_mfma_f32_32x32x16_bf16 v[16:31], v[92:95], v[88:91], v[72:87]
  ds_read_b128 v[96:99], v3 offset:7168
  v_exp_f32 v32, v32
  v_exp_f32 v33, v33
  v_exp_f32 v34, v34
  v_exp_f32 v35, v35
  v_exp_f32 v36, v36
  v_mfma_f32_32x32x16_bf16 v[56:71], v[104:107], v[52:55], v[56:71]
  ds_read_b128 v[100:103], v4 offset:6144
  v_exp_f32 v37, v37
  v_exp_f32 v38, v38
  v_exp_f32 v39, v39
  v_cvt_pk_bf16_f32 v48, v32, v33
  v_cvt_pk_bf16_f32 v49, v34, v35
  v_cvt_pk_bf16_f32 v50, v36, v37
  v_cvt_pk_bf16_f32 v51, v38, v39
  v_exp_f32 v40, v40
  v_exp_f32 v41, v41
  v_mfma_f32_32x32x16_bf16 v[56:71], v[108:111], v[48:51], v[56:71]
  ds_read_b128 v[112:115], v4 offset:5632
  v_exp_f32 v42, v42
  v_exp_f32 v43, v43
  v_exp_f32 v44, v44
  v_exp_f32 v45, v45
  v_exp_f32 v46, v46
  v_exp_f32 v47, v47
  v_cvt_pk_bf16_f32 v52, v40, v41
  v_cvt_pk_bf16_f32 v53, v42, v43
  v_cvt_pk_bf16_f32 v54, v44, v45
  v_cvt_pk_bf16_f32 v55, v46, v47
  s_waitcnt lgkmcnt(0)
  v_mfma_f32_32x32x16_bf16 v[32:47], v[96:99], v[88:91], v[72:87]
  ds_read_b128 v[92:95], v3 offset:8192
  v_exp_f32 v16, v16
  v_exp_f32 v17, v17
  v_exp_f32 v18, v18
  v_exp_f32 v19, v19
  v_exp_f32 v20, v20
  v_mfma_f32_32x32x16_bf16 v[56:71], v[112:115], v[52:55], v[56:71]
  ds_read_b128 v[108:111], v4 offset:7168
  v_exp_f32 v21, v21
  v_exp_f32 v22, v22
  v_exp_f32 v23, v23
  v_cvt_pk_bf16_f32 v48, v16, v17
  v_cvt_pk_bf16_f32 v49, v18, v19
  v_cvt_pk_bf16_f32 v50, v20, v21
  v_cvt_pk_bf16_f32 v51, v22, v23
  v_exp_f32 v24, v24
  v_exp_f32 v25, v25
  v_mfma_f32_32x32x16_bf16 v[56:71], v[100:103], v[48:51], v[56:71]
  ds_read_b128 v[104:107], v4 offset:6656
  v_exp_f32 v26, v26
  v_exp_f32 v27, v27
  v_exp_f32 v28, v28
  v_exp_f32 v29, v29
  v_exp_f32 v30, v30
  v_exp_f32 v31, v31
  v_cvt_pk_bf16_f32 v52, v24, v25
  v_cvt_pk_bf16_f32 v53, v26, v27
  v_cvt_pk_bf16_f32 v54, v28, v29
  v_cvt_pk_bf16_f32 v55, v30, v31
  s_waitcnt lgkmcnt(0)
  v_mfma_f32_32x32x16_bf16 v[16:31], v[92:95], v[88:91], v[72:87]
  ds_read_b128 v[96:99], v3 offset:9216
  v_exp_f32 v32, v32
  v_exp_f32 v33, v33
  v_exp_f32 v34, v34
  v_exp_f32 v35, v35
  v_exp_f32 v36, v36
  v_mfma_f32_32x32x16_bf16 v[56:71], v[104:107], v[52:55], v[56:71]
  ds_read_b128 v[100:103], v4 offset:8192
  v_exp_f32 v37, v37
  v_exp_f32 v38, v38
  v_exp_f32 v39, v39
  v_cvt_pk_bf16_f32 v48, v32, v33
  v_cvt_pk_bf16_f32 v49, v34, v35
  v_cvt_pk_bf16_f32 v50, v36, v37
  v_cvt_pk_bf16_f32 v51, v38, v39
  v_exp_f32 v40, v40
  v_exp_f32 v41, v41
  v_mfma_f32_32x32x16_bf16 v[56:71], v[108:111], v[48:51], v[56:71]
  ds_read_b128 v[112:115], v4 offset:7680
  v_exp_f32 v42, v42
  v_exp_f32 v43, v43
  v_exp_f32 v44, v44
  v_exp_f32 v45, v45
  v_exp_f32 v46, v46
  v_exp_f32 v47, v47
  v_add_u32 v3, 8192, v3
  v_add_u32 v4, v5, v4
  v_cvt_pk_bf16_f32 v52, v40, v41
  v_cvt_pk_bf16_f32 v53, v42, v43
  v_cvt_pk_bf16_f32 v54, v44, v45
  v_cvt_pk_bf16_f32 v55, v46, v47
  s_waitcnt vmcnt(0)
  s_barrier
  v_mov_b32 v140, 147456
  s_cmp_eq_u32 s34, 0
  s_cbranch_scc0 parallel_sum__mha_block__glu_gated_swiglu__prompt_kernel_s2w_16
  v_lshlrev_b32 v132, 0, v2
  v_add_u32 v132, 24645632, v132
  s_mov_b32 s77, 100000
parallel_sum__mha_block__glu_gated_swiglu__prompt_kernel_p2:
  buffer_load_dwordx4 v[136:139], v132, s[20:23], 0 offen sc1
  s_waitcnt vmcnt(0)
  v_cmp_ne_u32 vcc, s74, v136
  v_cmp_ne_u32 s[78:79], s74, v137
  s_or_b64 vcc, vcc, s[78:79]
  v_cmp_ne_u32 s[78:79], s74, v138
  s_or_b64 vcc, vcc, s[78:79]
  v_cmp_ne_u32 s[78:79], s74, v139
  s_or_b64 vcc, vcc, s[78:79]
  s_cmp_eq_u64 vcc, 0
  s_cbranch_scc1 parallel_sum__mha_block__glu_gated_swiglu__prompt_kernel_p2_ok
  s_sleep 4
  s_sub_u32 s77, s77, 1
  s_cmp_lg_u32 s77, 0
  s_cbranch_scc1 parallel_sum__mha_block__glu_gated_swiglu__prompt_kernel_p2
parallel_sum__mha_block__glu_gated_swiglu__prompt_kernel_p2_ok:
  v_mov_b32 v141, 1
  ds_write_b32 v140, v141
  s_branch parallel_sum__mha_block__glu_gated_swiglu__prompt_kernel_s2j_17
parallel_sum__mha_block__glu_gated_swiglu__prompt_kernel_s2w_16:
  s_mov_b32 s77, 1000000
parallel_sum__mha_block__glu_gated_swiglu__prompt_kernel_s2l_18:
  ds_read_b32 v141, v140
  s_waitcnt lgkmcnt(0)
  v_readfirstlane_b32 s78, v141
  s_cmp_eq_u32 s78, 1
  s_cbranch_scc1 parallel_sum__mha_block__glu_gated_swiglu__prompt_kernel_s2j_17
  s_sleep 1
  s_sub_u32 s77, s77, 1
  s_cmp_lg_u32 s77, 0
  s_cbranch_scc1 parallel_sum__mha_block__glu_gated_swiglu__prompt_kernel_s2l_18
parallel_sum__mha_block__glu_gated_swiglu__prompt_kernel_s2j_17:
  s_or_b32 s15, s2, s34
  s_cmp_eq_u32 s15, 0
  s_cbranch_scc0 parallel_sum__mha_block__glu_gated_swiglu__prompt_kernel_ep_19
  s_mov_b32 s15, 24653824
  v_mov_b32 v132, s74
  v_mov_b32 v133, 0
  buffer_store_dword v132, v133, s[20:23], s15 offen sc1
  s_waitcnt vmcnt(0)
parallel_sum__mha_block__glu_gated_swiglu__prompt_kernel_ep_19:
  s_waitcnt lgkmcnt(0)
  v_mfma_f32_32x32x16_bf16 v[32:47], v[96:99], v[88:91], v[72:87]
  ds_read_b128 v[92:95], v3 offset:2048
  v_exp_f32 v16, v16
  v_exp_f32 v17, v17
  v_exp_f32 v18, v18
  v_exp_f32 v19, v19
  v_exp_f32 v20, v20
  buffer_load_dwordx4 v[132:135], v2, s[28:31], s32 offen sc1
  buffer_load_dwordx4 v[136:139], v2, s[24:27], s32 offen sc1
  s_add_u32 s32, s32, 1024
  v_mfma_f32_32x32x16_bf16 v[56:71], v[112:115], v[52:55], v[56:71]
  ds_read_b128 v[108:111], v4 offset:1024
  v_exp_f32 v21, v21
  v_exp_f32 v22, v22
  v_exp_f32 v23, v23
  v_cvt_pk_bf16_f32 v48, v16, v17
  v_cvt_pk_bf16_f32 v49, v18, v19
  v_cvt_pk_bf16_f32 v50, v20, v21
  v_cvt_pk_bf16_f32 v51, v22, v23
  v_exp_f32 v24, v24
  v_exp_f32 v25, v25
  v_mfma_f32_32x32x16_bf16 v[56:71], v[100:103], v[48:51], v[56:71]
  ds_read_b128 v[104:107], v4 offset:512
  v_exp_f32 v26, v26
  v_exp_f32 v27, v27
  v_exp_f32 v28, v28
  buffer_load_dwordx4 v[140:143], v2, s[28:31], s32 offen sc1
  buffer_load_dwordx4 v[144:147], v2, s[24:27], s32 offen sc1
  s_add_u32 s32, s32, 1024
  v_exp_f32 v29, v29
  v_exp_f32 v30, v30
  v_exp_f32 v31, v31
  v_cvt_pk_bf16_f32 v52, v24, v25
  v_cvt_pk_bf16_f32 v53, v26, v27
  v_cvt_pk_bf16_f32 v54, v28, v29
  v_cvt_pk_bf16_f32 v55, v30, v31
  s_waitcnt lgkmcnt(0)
  v_mfma_f32_32x32x16_bf16 v[16:31], v[92:95], v[88:91], v[72:87]
  ds_read_b128 v[96:99], v3 offset:3072
  v_exp_f32 v32, v32
  v_exp_f32 v33, v33
  v_exp_f32 v34, v34
  v_exp_f32 v35, v35
  v_exp_f32 v36, v36
  buffer_load_dwordx4 v[148:151], v2, s[28:31], s32 offen sc1
  buffer_load_dwordx4 v[152:155], v2, s[24:27], s32 offen sc1
  s_add_u32 s32, s32, 1024
  v_mfma_f32_32x32x16_bf16 v[56:71], v[104:107], v[52:55], v[56:71]
  ds_read_b128 v[100:103], v4 offset:2048
  v_exp_f32 v37, v37
  v_exp_f32 v38, v38
  v_exp_f32 v39, v39
  v_cvt_pk_bf16_f32 v48, v32, v33
  v_cvt_pk_bf16_f32 v49, v34, v35
  v_cvt_pk_bf16_f32 v50, v36, v37
  v_cvt_pk_bf16_f32 v51, v38, v39
  v_exp_f32 v40, v40
  v_exp_f32 v41, v41
  v_mfma_f32_32x32x16_bf16 v[56:71], v[108:111], v[48:51], v[56:71]
  ds_read_b128 v[112:115], v4 offset:1536
  v_exp_f32 v42, v42
  v_exp_f32 v43, v43
  v_exp_f32 v44, v44
  buffer_load_dwordx4 v[156:159], v2, s[28:31], s32 offen sc1
  buffer_load_dwordx4 v[160:163], v2, s[24:27], s32 offen sc1
  s_add_u32 s32, s32, 1024
  v_exp_f32 v45, v45
  v_exp_f32 v46, v46
  v_exp_f32 v47, v47
  v_cvt_pk_bf16_f32 v52, v40, v41
  v_cvt_pk_bf16_f32 v53, v42, v43
  v_cvt_pk_bf16_f32 v54, v44, v45
  v_cvt_pk_bf16_f32 v55, v46, v47
  s_waitcnt lgkmcnt(0)
  v_mfma_f32_32x32x16_bf16 v[32:47], v[96:99], v[88:91], v[72:87]
  ds_read_b128 v[92:95], v3 offset:4096
  v_exp_f32 v16, v16
  v_exp_f32 v17, v17
  v_exp_f32 v18, v18
  v_exp_f32 v19, v19
  v_exp_f32 v20, v20
  buffer_load_dwordx4 v[164:167], v2, s[28:31], s32 offen sc1
  buffer_load_dwordx4 v[168:171], v2, s[24:27], s32 offen sc1
  s_add_u32 s32, s32, 1024
  v_mfma_f32_32x32x16_bf16 v[56:71], v[112:115], v[52:55], v[56:71]
  ds_read_b128 v[108:111], v4 offset:3072
  v_exp_f32 v21, v21
  v_exp_f32 v22, v22
  v_exp_f32 v23, v23
  v_cvt_pk_bf16_f32 v48, v16, v17
  v_cvt_pk_bf16_f32 v49, v18, v19
  v_cvt_pk_bf16_f32 v50, v20, v21
  v_cvt_pk_bf16_f32 v51, v22, v23
  v_exp_f32 v24, v24
  v_exp_f32 v25, v25
  v_mfma_f32_32x32x16_bf16 v[56:71], v[100:103], v[48:51], v[56:71]
  ds_read_b128 v[104:107], v4 offset:2560
  v_exp_f32 v26, v26
  v_exp_f32 v27, v27
  v_exp_f32 v28, v28
  buffer_load_dwordx4 v[172:175], v2, s[28:31], s32 offen sc1
  buffer_load_dwordx4 v[176:179], v2, s[24:27], s32 offen sc1
  s_add_u32 s32, s32, 1024
  v_exp_f32 v29, v29
  v_exp_f32 v30, v30
  v_exp_f32 v31, v31
  v_cvt_pk_bf16_f32 v52, v24, v25
  v_cvt_pk_bf16_f32 v53, v26, v27
  v_cvt_pk_bf16_f32 v54, v28, v29
  v_cvt_pk_bf16_f32 v55, v30, v31
  s_waitcnt lgkmcnt(0)
  v_mfma_f32_32x32x16_bf16 v[16:31], v[92:95], v[88:91], v[72:87]
  ds_read_b128 v[96:99], v3 offset:5120
  v_exp_f32 v32, v32
  v_exp_f32 v33, v33
  v_exp_f32 v34, v34
  v_exp_f32 v35, v35
  v_exp_f32 v36, v36
  buffer_load_dwordx4 v[180:183], v2, s[28:31], s32 offen sc1
  buffer_load_dwordx4 v[184:187], v2, s[24:27], s32 offen sc1
  s_add_u32 s32, s32, 1024
  v_mfma_f32_32x32x16_bf16 v[56:71], v[104:107], v[52:55], v[56:71]
  ds_read_b128 v[100:103], v4 offset:4096
  v_exp_f32 v37, v37
  v_exp_f32 v38, v38
  v_exp_f32 v39, v39
  v_cvt_pk_bf16_f32 v48, v32, v33
  v_cvt_pk_bf16_f32 v49, v34, v35
  v_cvt_pk_bf16_f32 v50, v36, v37
  v_cvt_pk_bf16_f32 v51, v38, v39
  v_exp_f32 v40, v40
  v_exp_f32 v41, v41
  v_mfma_f32_32x32x16_bf16 v[56:71], v[108:111], v[48:51], v[56:71]
  ds_read_b128 v[112:115], v4 offset:3584
  v_exp_f32 v42, v42
  v_exp_f32 v43, v43
  v_exp_f32 v44, v44
  buffer_load_dwordx4 v[188:191], v2, s[28:31], s32 offen sc1
  buffer_load_dwordx4 v[192:195], v2, s[24:27], s32 offen sc1
  s_add_u32 s32, s32, 1024
  v_exp_f32 v45, v45
  v_exp_f32 v46, v46
  v_exp_f32 v47, v47
  v_cvt_pk_bf16_f32 v52, v40, v41
  v_cvt_pk_bf16_f32 v53, v42, v43
  v_cvt_pk_bf16_f32 v54, v44, v45
  v_cvt_pk_bf16_f32 v55, v46, v47
  s_waitcnt lgkmcnt(0)
  v_mfma_f32_32x32x16_bf16 v[32:47], v[96:99], v[88:91], v[72:87]
  ds_read_b128 v[92:95], v3 offset:6144
  v_exp_f32 v16, v16
  v_exp_f32 v17, v17
  v_exp_f32 v18, v18
  v_exp_f32 v19, v19
  v_exp_f32 v20, v20
  v_mfma_f32_32x32x16_bf16 v[56:71], v[112:115], v[52:55], v[56:71]
  ds_read_b128 v[108:111], v4 offset:5120
  v_exp_f32 v21, v21
  v_exp_f32 v22, v22
  v_exp_f32 v23, v23
  v_cvt_pk_bf16_f32 v48, v16, v17
  v_cvt_pk_bf16_f32 v49, v18, v19
  v_cvt_pk_bf16_f32 v50, v20, v21
  v_cvt_pk_bf16_f32 v51, v22, v23
  v_exp_f32 v24, v24
  v_exp_f32 v25, v25
  v_mfma_f32_32x32x16_bf16 v[56:71], v[100:103], v[48:51], v[56:71]
  ds_read_b128 v[104:107], v4 offset:4608
  v_exp_f32 v26, v26
  v_exp_f32 v27, v27
  v_exp_f32 v28, v28
  v_exp_f32 v29, v29
  v_exp_f32 v30, v30
  v_exp_f32 v31, v31
  v_cvt_pk_bf16_f32 v52, v24, v25
  v_cvt_pk_bf16_f32 v53, v26, v27
  v_cvt_pk_bf16_f32 v54, v28, v29
  v_cvt_pk_bf16_f32 v55, v30, v31
  s_waitcnt lgkmcnt(0)
  v_mfma_f32_32x32x16_bf16 v[16:31], v[92:95], v[88:91], v[72:87]
  ds_read_b128 v[96:99], v3 offset:7168
  v_exp_f32 v32, v32
  v_exp_f32 v33, v33
  v_exp_f32 v34, v34
  v_exp_f32 v35, v35
  v_exp_f32 v36, v36
  s_waitcnt vmcnt(14)
  v_mfma_f32_32x32x16_bf16 v[116:131], v[132:135], v[136:139], 0
  buffer_load_dwordx4 v[132:135], v2, s[28:31], s32 offen sc1
  buffer_load_dwordx4 v[136:139], v2, s[24:27], s32 offen sc1
  s_add_u32 s32, s32, 1024
  v_mfma_f32_32x32x16_bf16 v[56:71], v[104:107], v[52:55], v[56:71]
  ds_read_b128 v[100:103], v4 offset:6144
  v_exp_f32 v37, v37
  v_exp_f32 v38, v38
  v_exp_f32 v39, v39
  v_cvt_pk_bf16_f32 v48, v32, v33
  v_cvt_pk_bf16_f32 v49, v34, v35
  v_cvt_pk_bf16_f32 v50, v36, v37
  v_cvt_pk_bf16_f32 v51, v38, v39
  v_exp_f32 v40, v40
  v_exp_f32 v41, v41
  v_mfma_f32_32x32x16_bf16 v[56:71], v[108:111], v[48:51], v[56:71]
  ds_read_b128 v[112:115], v4 offset:5632
  v_exp_f32 v42, v42
  v_exp_f32 v43, v43
  v_exp_f32 v44, v44
  s_waitcnt vmcnt(14)
  v_mfma_f32_32x32x16_bf16 v[116:131], v[140:143], v[144:147], v[116:131]
  buffer_load_dwordx4 v[140:143], v2, s[28:31], s32 offen sc1
  buffer_load_dwordx4 v[144:147], v2, s[24:27], s32 offen sc1
  s_add_u32 s32, s32, 1024
  v_exp_f32 v45, v45
  v_exp_f32 v46, v46
  v_exp_f32 v47, v47
  v_cvt_pk_bf16_f32 v52, v40, v41
  v_cvt_pk_bf16_f32 v53, v42, v43
  v_cvt_pk_bf16_f32 v54, v44, v45
  v_cvt_pk_bf16_f32 v55, v46, v47
  s_waitcnt lgkmcnt(0)
  v_mfma_f32_32x32x16_bf16 v[32:47], v[96:99], v[88:91], v[72:87]
  ds_read_b128 v[92:95], v3 offset:8192
  v_exp_f32 v16, v16
  v_exp_f32 v17, v17
  v_exp_f32 v18, v18
  v_exp_f32 v19, v19
  v_exp_f32 v20, v20
  s_waitcnt vmcnt(14)
  v_mfma_f32_32x32x16_bf16 v[116:131], v[148:151], v[152:155], v[116:131]
  buffer_load_dwordx4 v[148:151], v2, s[28:31], s32 offen sc1
  buffer_load_dwordx4 v[152:155], v2, s[24:27], s32 offen sc1
  s_add_u32 s32, s32, 1024
  v_mfma_f32_32x32x16_bf16 v[56:71], v[112:115], v[52:55], v[56:71]
  ds_read_b128 v[108:111], v4 offset:7168
  v_exp_f32 v21, v21
  v_exp_f32 v22, v22
  v_exp_f32 v23, v23
  v_cvt_pk_bf16_f32 v48, v16, v17
  v_cvt_pk_bf16_f32 v49, v18, v19
  v_cvt_pk_bf16_f32 v50, v20, v21
  v_cvt_pk_bf16_f32 v51, v22, v23
  v_exp_f32 v24, v24
  v_exp_f32 v25, v25
  v_mfma_f32_32x32x16_bf16 v[56:71], v[100:103], v[48:51], v[56:71]
  ds_read_b128 v[104:107], v4 offset:6656
  v_exp_f32 v26, v26
  v_exp_f32 v27, v27
  v_exp_f32 v28, v28
  s_waitcnt vmcnt(14)
  v_mfma_f32_32x32x16_bf16 v[116:131], v[156:159], v[160:163], v[116:131]
  buffer_load_dwordx4 v[156:159], v2, s[28:31], s32 offen sc1
  buffer_load_dwordx4 v[160:163], v2, s[24:27], s32 offen sc1
  s_add_u32 s32, s32, 1024
  v_exp_f32 v29, v29
  v_exp_f32 v30, v30
  v_exp_f32 v31, v31
  v_cvt_pk_bf16_f32 v52, v24, v25
  v_cvt_pk_bf16_f32 v53, v26, v27
  v_cvt_pk_bf16_f32 v54, v28, v29
  v_cvt_pk_bf16_f32 v55, v30, v31
  s_waitcnt lgkmcnt(0)
  v_mfma_f32_32x32x16_bf16 v[16:31], v[92:95], v[88:91], v[72:87]
  ds_read_b128 v[96:99], v3 offset:9216
  v_exp_f32 v32, v32
  v_exp_f32 v33, v33
  v_exp_f32 v34, v34
  v_exp_f32 v35, v35
  v_exp_f32 v36, v36
  s_waitcnt vmcnt(14)
  v_mfma_f32_32x32x16_bf16 v[116:131], v[164:167], v[168:171], v[116:131]
  buffer_load_dwordx4 v[164:167], v2, s[28:31], s32 offen sc1
  buffer_load_dwordx4 v[168:171], v2, s[24:27], s32 offen sc1
  s_add_u32 s32, s32, 1024
  v_mfma_f32_32x32x16_bf16 v[56:71], v[104:107], v[52:55], v[56:71]
  ds_read_b128 v[100:103], v4 offset:8192
  v_exp_f32 v37, v37
  v_exp_f32 v38, v38
  v_exp_f32 v39, v39
  v_cvt_pk_bf16_f32 v48, v32, v33
  v_cvt_pk_bf16_f32 v49, v34, v35
  v_cvt_pk_bf16_f32 v50, v36, v37
  v_cvt_pk_bf16_f32 v51, v38, v39
  v_exp_f32 v40, v40
  v_exp_f32 v41, v41
  v_mfma_f32_32x32x16_bf16 v[56:71], v[108:111], v[48:51], v[56:71]
  ds_read_b128 v[112:115], v4 offset:7680
  v_exp_f32 v42, v42
  v_exp_f32 v43, v43
  v_exp_f32 v44, v44
  s_waitcnt vmcnt(14)
  v_mfma_f32_32x32x16_bf16 v[116:131], v[172:175], v[176:179], v[116:131]
  buffer_load_dwordx4 v[172:175], v2, s[28:31], s32 offen sc1
  buffer_load_dwordx4 v[176:179], v2, s[24:27], s32 offen sc1
  s_add_u32 s32, s32, 1024
  v_exp_f32 v45, v45
  v_exp_f32 v46, v46
  v_exp_f32 v47, v47
  v_add_u32 v3, 8192, v3
  v_add_u32 v4, v5, v4
  v_cvt_pk_bf16_f32 v52, v40, v41
  v_cvt_pk_bf16_f32 v53, v42, v43
  v_cvt_pk_bf16_f32 v54, v44, v45
  v_cvt_pk_bf16_f32 v55, v46, v47
  s_mov_b32 s14, 5
.p2align 6
parallel_sum__mha_block__glu_gated_swiglu__prompt_kernel_oloop:
  s_waitcnt lgkmcnt(0)
  v_mfma_f32_32x32x16_bf16 v[32:47], v[96:99], v[88:91], v[72:87]
  ds_read_b128 v[92:95], v3 offset:2048
  v_exp_f32 v16, v16
  v_exp_f32 v17, v17
  v_exp_f32 v18, v18
  v_exp_f32 v19, v19
  v_exp_f32 v20, v20
  s_waitcnt vmcnt(14)
  v_mfma_f32_32x32x16_bf16 v[116:131], v[180:183], v[184:187], v[116:131]
  buffer_load_dwordx4 v[180:183], v2, s[28:31], s32 offen sc1
  buffer_load_dwordx4 v[184:187], v2, s[24:27], s32 offen sc1
  s_add_u32 s32, s32, 1024
  v_mfma_f32_32x32x16_bf16 v[56:71], v[112:115], v[52:55], v[56:71]
  ds_read_b128 v[108:111], v4 offset:1024
  v_exp_f32 v21, v21
  v_exp_f32 v22, v22
  v_exp_f32 v23, v23
  v_cvt_pk_bf16_f32 v48, v16, v17
  v_cvt_pk_bf16_f32 v49, v18, v19
  v_cvt_pk_bf16_f32 v50, v20, v21
  v_cvt_pk_bf16_f32 v51, v22, v23
  v_exp_f32 v24, v24
  v_exp_f32 v25, v25
  v_mfma_f32_32x32x16_bf16 v[56:71], v[100:103], v[48:51], v[56:71]
  ds_read_b128 v[104:107], v4 offset:512
  v_exp_f32 v26, v26
  v_exp_f32 v27, v27
  v_exp_f32 v28, v28
  s_waitcnt vmcnt(14)
  v_mfma_f32_32x32x16_bf16 v[116:131], v[188:191], v[192:195], v[116:131]
  buffer_load_dwordx4 v[188:191], v2, s[28:31], s32 offen sc1
  buffer_load_dwordx4 v[192:195], v2, s[24:27], s32 offen sc1
  s_add_u32 s32, s32, 1024
  v_exp_f32 v29, v29
  v_exp_f32 v30, v30
  v_exp_f32 v31, v31
  v_cvt_pk_bf16_f32 v52, v24, v25
  v_cvt_pk_bf16_f32 v53, v26, v27
  v_cvt_pk_bf16_f32 v54, v28, v29
  v_cvt_pk_bf16_f32 v55, v30, v31
  s_waitcnt lgkmcnt(0)
  v_mfma_f32_32x32x16_bf16 v[16:31], v[92:95], v[88:91], v[72:87]
  ds_read_b128 v[96:99], v3 offset:3072
  v_exp_f32 v32, v32
  v_exp_f32 v33, v33
  v_exp_f32 v34, v34
  v_exp_f32 v35, v35
  v_exp_f32 v36, v36
  s_waitcnt vmcnt(14)
  v_mfma_f32_32x32x16_bf16 v[116:131], v[132:135], v[136:139], v[116:131]
  buffer_load_dwordx4 v[132:135], v2, s[28:31], s32 offen sc1
  buffer_load_dwordx4 v[136:139], v2, s[24:27], s32 offen sc1
  s_add_u32 s32, s32, 1024
  v_mfma_f32_32x32x16_bf16 v[56:71], v[104:107], v[52:55], v[56:71]
  ds_read_b128 v[100:103], v4 offset:2048
  v_exp_f32 v37, v37
  v_exp_f32 v38, v38
  v_exp_f32 v39, v39
  v_cvt_pk_bf16_f32 v48, v32, v33
  v_cvt_pk_bf16_f32 v49, v34, v35
  v_cvt_pk_bf16_f32 v50, v36, v37
  v_cvt_pk_bf16_f32 v51, v38, v39
  v_exp_f32 v40, v40
  v_exp_f32 v41, v41
  v_mfma_f32_32x32x16_bf16 v[56:71], v[108:111], v[48:51], v[56:71]
  ds_read_b128 v[112:115], v4 offset:1536
  v_exp_f32 v42, v42
  v_exp_f32 v43, v43
  v_exp_f32 v44, v44
  s_waitcnt vmcnt(14)
  v_mfma_f32_32x32x16_bf16 v[116:131], v[140:143], v[144:147], v[116:131]
  buffer_load_dwordx4 v[140:143], v2, s[28:31], s32 offen sc1
  buffer_load_dwordx4 v[144:147], v2, s[24:27], s32 offen sc1
  s_add_u32 s32, s32, 1024
  v_exp_f32 v45, v45
  v_exp_f32 v46, v46
  v_exp_f32 v47, v47
  v_cvt_pk_bf16_f32 v52, v40, v41
  v_cvt_pk_bf16_f32 v53, v42, v43
  v_cvt_pk_bf16_f32 v54, v44, v45
  v_cvt_pk_bf16_f32 v55, v46, v47
  s_waitcnt lgkmcnt(0)
  v_mfma_f32_32x32x16_bf16 v[32:47], v[96:99], v[88:91], v[72:87]
  ds_read_b128 v[92:95], v3 offset:4096
  v_exp_f32 v16, v16
  v_exp_f32 v17, v17
  v_exp_f32 v18, v18
  v_exp_f32 v19, v19
  v_exp_f32 v20, v20
  s_waitcnt vmcnt(14)
  v_mfma_f32_32x32x16_bf16 v[116:131], v[148:151], v[152:155], v[116:131]
  buffer_load_dwordx4 v[148:151], v2, s[28:31], s32 offen sc1
  buffer_load_dwordx4 v[152:155], v2, s[24:27], s32 offen sc1
  s_add_u32 s32, s32, 1024
  v_mfma_f32_32x32x16_bf16 v[56:71], v[112:115], v[52:55], v[56:71]
  ds_read_b128 v[108:111], v4 offset:3072
  v_exp_f32 v21, v21
  v_exp_f32 v22, v22
  v_exp_f32 v23, v23
  v_cvt_pk_bf16_f32 v48, v16, v17
  v_cvt_pk_bf16_f32 v49, v18, v19
  v_cvt_pk_bf16_f32 v50, v20, v21
  v_cvt_pk_bf16_f32 v51, v22, v23
  v_exp_f32 v24, v24
  v_exp_f32 v25, v25
  v_mfma_f32_32x32x16_bf16 v[56:71], v[100:103], v[48:51], v[56:71]
  ds_read_b128 v[104:107], v4 offset:2560
  v_exp_f32 v26, v26
  v_exp_f32 v27, v27
  v_exp_f32 v28, v28
  s_waitcnt vmcnt(14)
  v_mfma_f32_32x32x16_bf16 v[116:131], v[156:159], v[160:163], v[116:131]
  buffer_load_dwordx4 v[156:159], v2, s[28:31], s32 offen sc1
  buffer_load_dwordx4 v[160:163], v2, s[24:27], s32 offen sc1
  s_add_u32 s32, s32, 1024
  v_exp_f32 v29, v29
  v_exp_f32 v30, v30
  v_exp_f32 v31, v31
  v_cvt_pk_bf16_f32 v52, v24, v25
  v_cvt_pk_bf16_f32 v53, v26, v27
  v_cvt_pk_bf16_f32 v54, v28, v29
  v_cvt_pk_bf16_f32 v55, v30, v31
  s_waitcnt lgkmcnt(0)
  v_mfma_f32_32x32x16_bf16 v[16:31], v[92:95], v[88:91], v[72:87]
  ds_read_b128 v[96:99], v3 offset:5120
  v_exp_f32 v32, v32
  v_exp_f32 v33, v33
  v_exp_f32 v34, v34
  v_exp_f32 v35, v35
  v_exp_f32 v36, v36
  s_waitcnt vmcnt(14)
  v_mfma_f32_32x32x16_bf16 v[116:131], v[164:167], v[168:171], v[116:131]
  buffer_load_dwordx4 v[164:167], v2, s[28:31], s32 offen sc1
  buffer_load_dwordx4 v[168:171], v2, s[24:27], s32 offen sc1
  s_add_u32 s32, s32, 1024
  v_mfma_f32_32x32x16_bf16 v[56:71], v[104:107], v[52:55], v[56:71]
  ds_read_b128 v[100:103], v4 offset:4096
  v_exp_f32 v37, v37
  v_exp_f32 v38, v38
  v_exp_f32 v39, v39
  v_cvt_pk_bf16_f32 v48, v32, v33
  v_cvt_pk_bf16_f32 v49, v34, v35
  v_cvt_pk_bf16_f32 v50, v36, v37
  v_cvt_pk_bf16_f32 v51, v38, v39
  v_exp_f32 v40, v40
  v_exp_f32 v41, v41
  v_mfma_f32_32x32x16_bf16 v[56:71], v[108:111], v[48:51], v[56:71]
  ds_read_b128 v[112:115], v4 offset:3584
  v_exp_f32 v42, v42
  v_exp_f32 v43, v43
  v_exp_f32 v44, v44
  s_waitcnt vmcnt(14)
  v_mfma_f32_32x32x16_bf16 v[116:131], v[172:175], v[176:179], v[116:131]
  buffer_load_dwordx4 v[172:175], v2, s[28:31], s32 offen sc1
  buffer_load_dwordx4 v[176:179], v2, s[24:27], s32 offen sc1
  s_add_u32 s32, s32, 1024
  v_exp_f32 v45, v45
  v_exp_f32 v46, v46
  v_exp_f32 v47, v47
  v_cvt_pk_bf16_f32 v52, v40, v41
  v_cvt_pk_bf16_f32 v53, v42, v43
  v_cvt_pk_bf16_f32 v54, v44, v45
  v_cvt_pk_bf16_f32 v55, v46, v47
  s_waitcnt lgkmcnt(0)
  v_mfma_f32_32x32x16_bf16 v[32:47], v[96:99], v[88:91], v[72:87]
  ds_read_b128 v[92:95], v3 offset:6144
  v_exp_f32 v16, v16
  v_exp_f32 v17, v17
  v_exp_f32 v18, v18
  v_exp_f32 v19, v19
  v_exp_f32 v20, v20
  s_waitcnt vmcnt(14)
  v_mfma_f32_32x32x16_bf16 v[116:131], v[180:183], v[184:187], v[116:131]
  buffer_load_dwordx4 v[180:183], v2, s[28:31], s32 offen sc1
  buffer_load_dwordx4 v[184:187], v2, s[24:27], s32 offen sc1
  s_add_u32 s32, s32, 1024
  v_mfma_f32_32x32x16_bf16 v[56:71], v[112:115], v[52:55], v[56:71]
  ds_read_b128 v[108:111], v4 offset:5120
  v_exp_f32 v21, v21
  v_exp_f32 v22, v22
  v_exp_f32 v23, v23
  v_cvt_pk_bf16_f32 v48, v16, v17
  v_cvt_pk_bf16_f32 v49, v18, v19
  v_cvt_pk_bf16_f32 v50, v20, v21
  v_cvt_pk_bf16_f32 v51, v22, v23
  v_exp_f32 v24, v24
  v_exp_f32 v25, v25
  v_mfma_f32_32x32x16_bf16 v[56:71], v[100:103], v[48:51], v[56:71]
  ds_read_b128 v[104:107], v4 offset:4608
  v_exp_f32 v26, v26
  v_exp_f32 v27, v27
  v_exp_f32 v28, v28
  s_waitcnt vmcnt(14)
  v_mfma_f32_32x32x16_bf16 v[116:131], v[188:191], v[192:195], v[116:131]
  buffer_load_dwordx4 v[188:191], v2, s[28:31], s32 offen sc1
  buffer_load_dwordx4 v[192:195], v2, s[24:27], s32 offen sc1
  s_add_u32 s32, s32, 1024
  v_exp_f32 v29, v29
  v_exp_f32 v30, v30
  v_exp_f32 v31, v31
  v_cvt_pk_bf16_f32 v52, v24, v25
  v_cvt_pk_bf16_f32 v53, v26, v27
  v_cvt_pk_bf16_f32 v54, v28, v29
  v_cvt_pk_bf16_f32 v55, v30, v31
  s_waitcnt lgkmcnt(0)
  v_mfma_f32_32x32x16_bf16 v[16:31], v[92:95], v[88:91], v[72:87]
  ds_read_b128 v[96:99], v3 offset:7168
  v_exp_f32 v32, v32
  v_exp_f32 v33, v33
  v_exp_f32 v34, v34
  v_exp_f32 v35, v35
  v_exp_f32 v36, v36
  s_waitcnt vmcnt(14)
  v_mfma_f32_32x32x16_bf16 v[116:131], v[132:135], v[136:139], v[116:131]
  buffer_load_dwordx4 v[132:135], v2, s[28:31], s32 offen sc1
  buffer_load_dwordx4 v[136:139], v2, s[24:27], s32 offen sc1
  s_add_u32 s32, s32, 1024
  v_mfma_f32_32x32x16_bf16 v[56:71], v[104:107], v[52:55], v[56:71]
  ds_read_b128 v[100:103], v4 offset:6144
  v_exp_f32 v37, v37
  v_exp_f32 v38, v38
  v_exp_f32 v39, v39
  v_cvt_pk_bf16_f32 v48, v32, v33
  v_cvt_pk_bf16_f32 v49, v34, v35
  v_cvt_pk_bf16_f32 v50, v36, v37
  v_cvt_pk_bf16_f32 v51, v38, v39
  v_exp_f32 v40, v40
  v_exp_f32 v41, v41
  v_mfma_f32_32x32x16_bf16 v[56:71], v[108:111], v[48:51], v[56:71]
  ds_read_b128 v[112:115], v4 offset:5632
  v_exp_f32 v42, v42
  v_exp_f32 v43, v43
  v_exp_f32 v44, v44
  s_waitcnt vmcnt(14)
  v_mfma_f32_32x32x16_bf16 v[116:131], v[140:143], v[144:147], v[116:131]
  buffer_load_dwordx4 v[140:143], v2, s[28:31], s32 offen sc1
  buffer_load_dwordx4 v[144:147], v2, s[24:27], s32 offen sc1
  s_add_u32 s32, s32, 1024
  v_exp_f32 v45, v45
  v_exp_f32 v46, v46
  v_exp_f32 v47, v47
  v_cvt_pk_bf16_f32 v52, v40, v41
  v_cvt_pk_bf16_f32 v53, v42, v43
  v_cvt_pk_bf16_f32 v54, v44, v45
  v_cvt_pk_bf16_f32 v55, v46, v47
  s_waitcnt lgkmcnt(0)
  v_mfma_f32_32x32x16_bf16 v[32:47], v[96:99], v[88:91], v[72:87]
  ds_read_b128 v[92:95], v3 offset:8192
  v_exp_f32 v16, v16
  v_exp_f32 v17, v17
  v_exp_f32 v18, v18
  v_exp_f32 v19, v19
  v_exp_f32 v20, v20
  s_waitcnt vmcnt(14)
  v_mfma_f32_32x32x16_bf16 v[116:131], v[148:151], v[152:155], v[116:131]
  buffer_load_dwordx4 v[148:151], v2, s[28:31], s32 offen sc1
  buffer_load_dwordx4 v[152:155], v2, s[24:27], s32 offen sc1
  s_add_u32 s32, s32, 1024
  v_mfma_f32_32x32x16_bf16 v[56:71], v[112:115], v[52:55], v[56:71]
  ds_read_b128 v[108:111], v4 offset:7168
  v_exp_f32 v21, v21
  v_exp_f32 v22, v22
  v_exp_f32 v23, v23
  v_cvt_pk_bf16_f32 v48, v16, v17
  v_cvt_pk_bf16_f32 v49, v18, v19
  v_cvt_pk_bf16_f32 v50, v20, v21
  v_cvt_pk_bf16_f32 v51, v22, v23
  v_exp_f32 v24, v24
  v_exp_f32 v25, v25
  v_mfma_f32_32x32x16_bf16 v[56:71], v[100:103], v[48:51], v[56:71]
  ds_read_b128 v[104:107], v4 offset:6656
  v_exp_f32 v26, v26
  v_exp_f32 v27, v27
  v_exp_f32 v28, v28
  s_waitcnt vmcnt(14)
  v_mfma_f32_32x32x16_bf16 v[116:131], v[156:159], v[160:163], v[116:131]
  buffer_load_dwordx4 v[156:159], v2, s[28:31], s32 offen sc1
  buffer_load_dwordx4 v[160:163], v2, s[24:27], s32 offen sc1
  s_add_u32 s32, s32, 1024
  v_exp_f32 v29, v29
  v_exp_f32 v30, v30
  v_exp_f32 v31, v31
  v_cvt_pk_bf16_f32 v52, v24, v25
  v_cvt_pk_bf16_f32 v53, v26, v27
  v_cvt_pk_bf16_f32 v54, v28, v29
  v_cvt_pk_bf16_f32 v55, v30, v31
  s_waitcnt lgkmcnt(0)
  v_mfma_f32_32x32x16_bf16 v[16:31], v[92:95], v[88:91], v[72:87]
  ds_read_b128 v[96:99], v3 offset:9216
  v_exp_f32 v32, v32
  v_exp_f32 v33, v33
  v_exp_f32 v34, v34
  v_exp_f32 v35, v35
  v_exp_f32 v36, v36
  s_waitcnt vmcnt(14)
  v_mfma_f32_32x32x16_bf16 v[116:131], v[164:167], v[168:171], v[116:131]
  buffer_load_dwordx4 v[164:167], v2, s[28:31], s32 offen sc1
  buffer_load_dwordx4 v[168:171], v2, s[24:27], s32 offen sc1
  s_add_u32 s32, s32, 1024
  v_mfma_f32_32x32x16_bf16 v[56:71], v[104:107], v[52:55], v[56:71]
  ds_read_b128 v[100:103], v4 offset:8192
  v_exp_f32 v37, v37
  v_exp_f32 v38, v38
  v_exp_f32 v39, v39
  v_cvt_pk_bf16_f32 v48, v32, v33
  v_cvt_pk_bf16_f32 v49, v34, v35
  v_cvt_pk_bf16_f32 v50, v36, v37
  v_cvt_pk_bf16_f32 v51, v38, v39
  v_exp_f32 v40, v40
  v_exp_f32 v41, v41
  v_mfma_f32_32x32x16_bf16 v[56:71], v[108:111], v[48:51], v[56:71]
  ds_read_b128 v[112:115], v4 offset:7680
  v_exp_f32 v42, v42
  v_exp_f32 v43, v43
  v_exp_f32 v44, v44
  s_waitcnt vmcnt(14)
  v_mfma_f32_32x32x16_bf16 v[116:131], v[172:175], v[176:179], v[116:131]
  buffer_load_dwordx4 v[172:175], v2, s[28:31], s32 offen sc1
  buffer_load_dwordx4 v[176:179], v2, s[24:27], s32 offen sc1
  s_add_u32 s32, s32, 1024
  v_exp_f32 v45, v45
  v_exp_f32 v46, v46
  v_exp_f32 v47, v47
  v_add_u32 v3, 8192, v3
  v_add_u32 v4, v5, v4
  v_cvt_pk_bf16_f32 v52, v40, v41
  v_cvt_pk_bf16_f32 v53, v42, v43
  v_cvt_pk_bf16_f32 v54, v44, v45
  v_cvt_pk_bf16_f32 v55, v46, v47
  s_sub_u32 s14, s14, 1
  s_cmp_lg_u32 s14, 0
  s_cbranch_scc1 parallel_sum__mha_block__glu_gated_swiglu__prompt_kernel_oloop
  s_setprio 0
  s_waitcnt lgkmcnt(0)
  v_mfma_f32_32x32x16_bf16 v[56:71], v[112:115], v[52:55], v[56:71]
  s_lshl_b32 s15, s10, 15
  s_lshl_b32 s16, s8, 10
  s_add_u32 s15, s15, s16
  s_add_u32 s15, s15, 12582912
  s_nop 15
  v_rcp_f32 v10, v64
  s_nop 0
  v_mul_f32 v56, v10, v56
  v_mul_f32 v57, v10, v57
  v_mul_f32 v58, v10, v58
  v_mul_f32 v59, v10, v59
  v_mul_f32 v60, v10, v60
  v_mul_f32 v61, v10, v61
  v_mul_f32 v62, v10, v62
  v_mul_f32 v63, v10, v63
  v_cvt_pk_bf16_f32 v48, v56, v57
  v_cvt_pk_bf16_f32 v49, v58, v59
  v_cvt_pk_bf16_f32 v50, v60, v61
  v_cvt_pk_bf16_f32 v51, v62, v63
  buffer_store_dwordx4 v[48:51], v2, s[20:23], s15 offen sc1
  s_waitcnt vmcnt(1)
  s_add_u32 s15, s33, 0
  buffer_load_dwordx4 v[132:135], v2, s[20:23], s15 offen sc1
  s_add_u32 s15, s33, 1024
  buffer_load_dwordx4 v[136:139], v2, s[20:23], s15 offen sc1
  s_add_u32 s15, s33, 2048
  buffer_load_dwordx4 v[140:143], v2, s[20:23], s15 offen sc1
  s_add_u32 s15, s33, 3072
  buffer_load_dwordx4 v[144:147], v2, s[20:23], s15 offen sc1
  s_add_u32 s15, s33, 4096
  buffer_load_dwordx4 v[148:151], v2, s[20:23], s15 offen sc1
  s_add_u32 s15, s33, 5120
  buffer_load_dwordx4 v[152:155], v2, s[20:23], s15 offen sc1
  s_add_u32 s15, s33, 6144
  buffer_load_dwordx4 v[156:159], v2, s[20:23], s15 offen sc1
  s_add_u32 s15, s33, 7168
  buffer_load_dwordx4 v[160:163], v2, s[20:23], s15 offen sc1
  s_add_u32 s15, s33, 8192
  buffer_load_dwordx4 v[164:167], v2, s[20:23], s15 offen sc1
  s_add_u32 s15, s33, 9216
  buffer_load_dwordx4 v[168:171], v2, s[20:23], s15 offen sc1
  s_add_u32 s15, s33, 10240
  buffer_load_dwordx4 v[172:175], v2, s[20:23], s15 offen sc1
  s_add_u32 s15, s33, 11264
  buffer_load_dwordx4 v[176:179], v2, s[20:23], s15 offen sc1
  s_add_u32 s15, s33, 12288
  buffer_load_dwordx4 v[180:183], v2, s[20:23], s15 offen sc1
  s_add_u32 s15, s33, 13312
  buffer_load_dwordx4 v[184:187], v2, s[20:23], s15 offen sc1
  s_add_u32 s15, s33, 14336
  buffer_load_dwordx4 v[188:191], v2, s[20:23], s15 offen sc1
  s_add_u32 s15, s33, 15360
  buffer_load_dwordx4 v[192:195], v2, s[20:23], s15 offen sc1
  s_branch parallel_sum__mha_block__glu_gated_swiglu__prompt_kernel_ph3
parallel_sum__mha_block__glu_gated_swiglu__prompt_kernel_young:
  s_waitcnt lgkmcnt(0)
  v_mfma_f32_32x32x16_bf16 v[32:47], v[96:99], v[88:91], v[72:87]
  ds_read_b128 v[92:95], v3 offset:2048
  v_exp_f32 v16, v16
  v_exp_f32 v17, v17
  v_exp_f32 v18, v18
  v_exp_f32 v19, v19
  v_exp_f32 v20, v20
  ds_read_b128 v[108:111], v4 offset:1024
  v_exp_f32 v21, v21
  v_exp_f32 v22, v22
  v_exp_f32 v23, v23
  v_cvt_pk_bf16_f32 v48, v16, v17
  v_cvt_pk_bf16_f32 v49, v18, v19
  v_cvt_pk_bf16_f32 v50, v20, v21
  v_cvt_pk_bf16_f32 v51, v22, v23
  v_exp_f32 v24, v24
  v_exp_f32 v25, v25
  v_mfma_f32_32x32x16_bf16 v[56:71], v[100:103], v[48:51], 0
  ds_read_b128 v[104:107], v4 offset:512
  v_exp_f32 v26, v26
  v_exp_f32 v27, v27
  v_exp_f32 v28, v28
  v_exp_f32 v29, v29
  v_exp_f32 v30, v30
  v_exp_f32 v31, v31
  v_cvt_pk_bf16_f32 v52, v24, v25
  v_cvt_pk_bf16_f32 v53, v26, v27
  v_cvt_pk_bf16_f32 v54, v28, v29
  v_cvt_pk_bf16_f32 v55, v30, v31
  s_waitcnt lgkmcnt(0)
  v_mfma_f32_32x32x16_bf16 v[16:31], v[92:95], v[88:91], v[72:87]
  ds_read_b128 v[96:99], v3 offset:3072
  v_exp_f32 v32, v32
  v_exp_f32 v33, v33
  v_exp_f32 v34, v34
  v_exp_f32 v35, v35
  v_exp_f32 v36, v36
  v_mfma_f32_32x32x16_bf16 v[56:71], v[104:107], v[52:55], v[56:71]
  ds_read_b128 v[100:103], v4 offset:2048
  v_exp_f32 v37, v37
  v_exp_f32 v38, v38
  v_exp_f32 v39, v39
  v_cvt_pk_bf16_f32 v48, v32, v33
  v_cvt_pk_bf16_f32 v49, v34, v35
  v_cvt_pk_bf16_f32 v50, v36, v37
  v_cvt_pk_bf16_f32 v51, v38, v39
  v_exp_f32 v40, v40
  v_exp_f32 v41, v41
  v_mfma_f32_32x32x16_bf16 v[56:71], v[108:111], v[48:51], v[56:71]
  ds_read_b128 v[112:115], v4 offset:1536
  v_exp_f32 v42, v42
  v_exp_f32 v43, v43
  v_exp_f32 v44, v44
  v_exp_f32 v45, v45
  v_exp_f32 v46, v46
  v_exp_f32 v47, v47
  v_cvt_pk_bf16_f32 v52, v40, v41
  v_cvt_pk_bf16_f32 v53, v42, v43
  v_cvt_pk_bf16_f32 v54, v44, v45
  v_cvt_pk_bf16_f32 v55, v46, v47
  s_waitcnt lgkmcnt(0)
  v_mfma_f32_32x32x16_bf16 v[32:47], v[96:99], v[88:91], v[72:87]
  ds_read_b128 v[92:95], v3 offset:4096
  v_exp_f32 v16, v16
  v_exp_f32 v17, v17
  v_exp_f32 v18, v18
  v_exp_f32 v19, v19
  v_exp_f32 v20, v20
  v_mfma_f32_32x32x16_bf16 v[56:71], v[112:115], v[52:55], v[56:71]
  ds_read_b128 v[108:111], v4 offset:3072
  v_exp_f32 v21, v21
  v_exp_f32 v22, v22
  v_exp_f32 v23, v23
  v_cvt_pk_bf16_f32 v48, v16, v17
  v_cvt_pk_bf16_f32 v49, v18, v19
  v_cvt_pk_bf16_f32 v50, v20, v21
  v_cvt_pk_bf16_f32 v51, v22, v23
  v_exp_f32 v24, v24
  v_exp_f32 v25, v25
  v_mfma_f32_32x32x16_bf16 v[56:71], v[100:103], v[48:51], v[56:71]
  ds_read_b128 v[104:107], v4 offset:2560
  v_exp_f32 v26, v26
  v_exp_f32 v27, v27
  v_exp_f32 v28, v28
  v_exp_f32 v29, v29
  v_exp_f32 v30, v30
  v_exp_f32 v31, v31
  v_cvt_pk_bf16_f32 v52, v24, v25
  v_cvt_pk_bf16_f32 v53, v26, v27
  v_cvt_pk_bf16_f32 v54, v28, v29
  v_cvt_pk_bf16_f32 v55, v30, v31
  s_waitcnt lgkmcnt(0)
  v_mfma_f32_32x32x16_bf16 v[16:31], v[92:95], v[88:91], v[72:87]
  ds_read_b128 v[96:99], v3 offset:5120
  v_exp_f32 v32, v32
  v_exp_f32 v33, v33
  v_exp_f32 v34, v34
  v_exp_f32 v35, v35
  v_exp_f32 v36, v36
  v_mfma_f32_32x32x16_bf16 v[56:71], v[104:107], v[52:55], v[56:71]
  ds_read_b128 v[100:103], v4 offset:4096
  v_exp_f32 v37, v37
  v_exp_f32 v38, v38
  v_exp_f32 v39, v39
  v_cvt_pk_bf16_f32 v48, v32, v33
  v_cvt_pk_bf16_f32 v49, v34, v35
  v_cvt_pk_bf16_f32 v50, v36, v37
  v_cvt_pk_bf16_f32 v51, v38, v39
  v_exp_f32 v40, v40
  v_exp_f32 v41, v41
  v_mfma_f32_32x32x16_bf16 v[56:71], v[108:111], v[48:51], v[56:71]
  ds_read_b128 v[112:115], v4 offset:3584
  v_exp_f32 v42, v42
  v_exp_f32 v43, v43
  v_exp_f32 v44, v44
  v_exp_f32 v45, v45
  v_exp_f32 v46, v46
  v_exp_f32 v47, v47
  v_cvt_pk_bf16_f32 v52, v40, v41
  v_cvt_pk_bf16_f32 v53, v42, v43
  v_cvt_pk_bf16_f32 v54, v44, v45
  v_cvt_pk_bf16_f32 v55, v46, v47
  s_waitcnt lgkmcnt(0)
  v_mfma_f32_32x32x16_bf16 v[32:47], v[96:99], v[88:91], v[72:87]
  ds_read_b128 v[92:95], v3 offset:6144
  v_exp_f32 v16, v16
  v_exp_f32 v17, v17
  v_exp_f32 v18, v18
  v_exp_f32 v19, v19
  v_exp_f32 v20, v20
  v_mfma_f32_32x32x16_bf16 v[56:71], v[112:115], v[52:55], v[56:71]
  ds_read_b128 v[108:111], v4 offset:5120
  v_exp_f32 v21, v21
  v_exp_f32 v22, v22
  v_exp_f32 v23, v23
  v_cvt_pk_bf16_f32 v48, v16, v17
  v_cvt_pk_bf16_f32 v49, v18, v19
  v_cvt_pk_bf16_f32 v50, v20, v21
  v_cvt_pk_bf16_f32 v51, v22, v23
  v_exp_f32 v24, v24
  v_exp_f32 v25, v25
  v_mfma_f32_32x32x16_bf16 v[56:71], v[100:103], v[48:51], v[56:71]
  ds_read_b128 v[104:107], v4 offset:4608
  v_exp_f32 v26, v26
  v_exp_f32 v27, v27
  v_exp_f32 v28, v28
  v_exp_f32 v29, v29
  v_exp_f32 v30, v30
  v_exp_f32 v31, v31
  v_cvt_pk_bf16_f32 v52, v24, v25
  v_cvt_pk_bf16_f32 v53, v26, v27
  v_cvt_pk_bf16_f32 v54, v28, v29
  v_cvt_pk_bf16_f32 v55, v30, v31
  s_waitcnt lgkmcnt(0)
  v_mfma_f32_32x32x16_bf16 v[16:31], v[92:95], v[88:91], v[72:87]
  ds_read_b128 v[96:99], v3 offset:7168
  v_exp_f32 v32, v32
  v_exp_f32 v33, v33
  v_exp_f32 v34, v34
  v_exp_f32 v35, v35
  v_exp_f32 v36, v36
  v_mfma_f32_32x32x16_bf16 v[56:71], v[104:107], v[52:55], v[56:71]
  ds_read_b128 v[100:103], v4 offset:6144
  v_exp_f32 v37, v37
  v_exp_f32 v38, v38
  v_exp_f32 v39, v39
  v_cvt_pk_bf16_f32 v48, v32, v33
  v_cvt_pk_bf16_f32 v49, v34, v35
  v_cvt_pk_bf16_f32 v50, v36, v37
  v_cvt_pk_bf16_f32 v51, v38, v39
  v_exp_f32 v40, v40
  v_exp_f32 v41, v41
  v_mfma_f32_32x32x16_bf16 v[56:71], v[108:111], v[48:51], v[56:71]
  ds_read_b128 v[112:115], v4 offset:5632
  v_exp_f32 v42, v42
  v_exp_f32 v43, v43
  v_exp_f32 v44, v44
  v_exp_f32 v45, v45
  v_exp_f32 v46, v46
  v_exp_f32 v47, v47
  v_cvt_pk_bf16_f32 v52, v40, v41
  v_cvt_pk_bf16_f32 v53, v42, v43
  v_cvt_pk_bf16_f32 v54, v44, v45
  v_cvt_pk_bf16_f32 v55, v46, v47
  s_waitcnt lgkmcnt(0)
  v_mfma_f32_32x32x16_bf16 v[32:47], v[96:99], v[88:91], v[72:87]
  ds_read_b128 v[92:95], v3 offset:8192
  v_exp_f32 v16, v16
  v_exp_f32 v17, v17
  v_exp_f32 v18, v18
  v_exp_f32 v19, v19
  v_exp_f32 v20, v20
  v_mfma_f32_32x32x16_bf16 v[56:71], v[112:115], v[52:55], v[56:71]
  ds_read_b128 v[108:111], v4 offset:7168
  v_exp_f32 v21, v21
  v_exp_f32 v22, v22
  v_exp_f32 v23, v23
  v_cvt_pk_bf16_f32 v48, v16, v17
  v_cvt_pk_bf16_f32 v49, v18, v19
  v_cvt_pk_bf16_f32 v50, v20, v21
  v_cvt_pk_bf16_f32 v51, v22, v23
  v_exp_f32 v24, v24
  v_exp_f32 v25, v25
  v_mfma_f32_32x32x16_bf16 v[56:71], v[100:103], v[48:51], v[56:71]
  ds_read_b128 v[104:107], v4 offset:6656
  v_exp_f32 v26, v26
  v_exp_f32 v27, v27
  v_exp_f32 v28, v28
  v_exp_f32 v29, v29
  v_exp_f32 v30, v30
  v_exp_f32 v31, v31
  v_cvt_pk_bf16_f32 v52, v24, v25
  v_cvt_pk_bf16_f32 v53, v26, v27
  v_cvt_pk_bf16_f32 v54, v28, v29
  v_cvt_pk_bf16_f32 v55, v30, v31
  s_waitcnt lgkmcnt(0)
  v_mfma_f32_32x32x16_bf16 v[16:31], v[92:95], v[88:91], v[72:87]
  ds_read_b128 v[96:99], v3 offset:9216
  v_exp_f32 v32, v32
  v_exp_f32 v33, v33
  v_exp_f32 v34, v34
  v_exp_f32 v35, v35
  v_exp_f32 v36, v36
  v_mfma_f32_32x32x16_bf16 v[56:71], v[104:107], v[52:55], v[56:71]
  ds_read_b128 v[100:103], v4 offset:8192
  v_exp_f32 v37, v37
  v_exp_f32 v38, v38
  v_exp_f32 v39, v39
  v_cvt_pk_bf16_f32 v48, v32, v33
  v_cvt_pk_bf16_f32 v49, v34, v35
  v_cvt_pk_bf16_f32 v50, v36, v37
  v_cvt_pk_bf16_f32 v51, v38, v39
  v_exp_f32 v40, v40
  v_exp_f32 v41, v41
  v_mfma_f32_32x32x16_bf16 v[56:71], v[108:111], v[48:51], v[56:71]
  ds_read_b128 v[112:115], v4 offset:7680
  v_exp_f32 v42, v42
  v_exp_f32 v43, v43
  v_exp_f32 v44, v44
  v_exp_f32 v45, v45
  v_exp_f32 v46, v46
  v_exp_f32 v47, v47
  v_add_u32 v3, 8192, v3
  v_add_u32 v4, v5, v4
  v_cvt_pk_bf16_f32 v52, v40, v41
  v_cvt_pk_bf16_f32 v53, v42, v43
  v_cvt_pk_bf16_f32 v54, v44, v45
  v_cvt_pk_bf16_f32 v55, v46, v47
  s_waitcnt vmcnt(0)
  s_barrier
  s_cmp_eq_u32 s34, 4
  s_cbranch_scc0 parallel_sum__mha_block__glu_gated_swiglu__prompt_kernel_s2_20
  s_lshl_b32 s15, s2, 2
  s_add_u32 s15, s15, 24645632
  v_mov_b32 v116, s74
  v_mov_b32 v117, 0
  buffer_store_dword v116, v117, s[20:23], s15 offen sc1
parallel_sum__mha_block__glu_gated_swiglu__prompt_kernel_s2_20:
  s_waitcnt lgkmcnt(0)
  v_mfma_f32_32x32x16_bf16 v[32:47], v[96:99], v[88:91], v[72:87]
  ds_read_b128 v[92:95], v3 offset:2048
  v_exp_f32 v16, v16
  v_exp_f32 v17, v17
  v_exp_f32 v18, v18
  v_exp_f32 v19, v19
  v_exp_f32 v20, v20
  v_mfma_f32_32x32x16_bf16 v[56:71], v[112:115], v[52:55], v[56:71]
  ds_read_b128 v[108:111], v4 offset:1024
  v_exp_f32 v21, v21
  v_exp_f32 v22, v22
  v_exp_f32 v23, v23
  v_cvt_pk_bf16_f32 v48, v16, v17
  v_cvt_pk_bf16_f32 v49, v18, v19
  v_cvt_pk_bf16_f32 v50, v20, v21
  v_cvt_pk_bf16_f32 v51, v22, v23
  v_exp_f32 v24, v24
  v_exp_f32 v25, v25
  v_mfma_f32_32x32x16_bf16 v[56:71], v[100:103], v[48:51], v[56:71]
  ds_read_b128 v[104:107], v4 offset:512
  v_exp_f32 v26, v26
  v_exp_f32 v27, v27
  v_exp_f32 v28, v28
  v_exp_f32 v29, v29
  v_exp_f32 v30, v30
  v_exp_f32 v31, v31
  v_cvt_pk_bf16_f32 v52, v24, v25
  v_cvt_pk_bf16_f32 v53, v26, v27
  v_cvt_pk_bf16_f32 v54, v28, v29
  v_cvt_pk_bf16_f32 v55, v30, v31
  s_waitcnt lgkmcnt(0)
  v_mfma_f32_32x32x16_bf16 v[16:31], v[92:95], v[88:91], v[72:87]
  ds_read_b128 v[96:99], v3 offset:3072
  v_exp_f32 v32, v32
  v_exp_f32 v33, v33
  v_exp_f32 v34, v34
  v_exp_f32 v35, v35
  v_exp_f32 v36, v36
  v_mfma_f32_32x32x16_bf16 v[56:71], v[104:107], v[52:55], v[56:71]
  ds_read_b128 v[100:103], v4 offset:2048
  v_exp_f32 v37, v37
  v_exp_f32 v38, v38
  v_exp_f32 v39, v39
  v_cvt_pk_bf16_f32 v48, v32, v33
  v_cvt_pk_bf16_f32 v49, v34, v35
  v_cvt_pk_bf16_f32 v50, v36, v37
  v_cvt_pk_bf16_f32 v51, v38, v39
  v_exp_f32 v40, v40
  v_exp_f32 v41, v41
  v_mfma_f32_32x32x16_bf16 v[56:71], v[108:111], v[48:51], v[56:71]
  ds_read_b128 v[112:115], v4 offset:1536
  v_exp_f32 v42, v42
  v_exp_f32 v43, v43
  v_exp_f32 v44, v44
  v_exp_f32 v45, v45
  v_exp_f32 v46, v46
  v_exp_f32 v47, v47
  v_cvt_pk_bf16_f32 v52, v40, v41
  v_cvt_pk_bf16_f32 v53, v42, v43
  v_cvt_pk_bf16_f32 v54, v44, v45
  v_cvt_pk_bf16_f32 v55, v46, v47
  s_waitcnt lgkmcnt(0)
  v_mfma_f32_32x32x16_bf16 v[32:47], v[96:99], v[88:91], v[72:87]
  ds_read_b128 v[92:95], v3 offset:4096
  v_exp_f32 v16, v16
  v_exp_f32 v17, v17
  v_exp_f32 v18, v18
  v_exp_f32 v19, v19
  v_exp_f32 v20, v20
  v_mfma_f32_32x32x16_bf16 v[56:71], v[112:115], v[52:55], v[56:71]
  ds_read_b128 v[108:111], v4 offset:3072
  v_exp_f32 v21, v21
  v_exp_f32 v22, v22
  v_exp_f32 v23, v23
  v_cvt_pk_bf16_f32 v48, v16, v17
  v_cvt_pk_bf16_f32 v49, v18, v19
  v_cvt_pk_bf16_f32 v50, v20, v21
  v_cvt_pk_bf16_f32 v51, v22, v23
  v_exp_f32 v24, v24
  v_exp_f32 v25, v25
  v_mfma_f32_32x32x16_bf16 v[56:71], v[100:103], v[48:51], v[56:71]
  ds_read_b128 v[104:107], v4 offset:2560
  v_exp_f32 v26, v26
  v_exp_f32 v27, v27
  v_exp_f32 v28, v28
  v_exp_f32 v29, v29
  v_exp_f32 v30, v30
  v_exp_f32 v31, v31
  v_cvt_pk_bf16_f32 v52, v24, v25
  v_cvt_pk_bf16_f32 v53, v26, v27
  v_cvt_pk_bf16_f32 v54, v28, v29
  v_cvt_pk_bf16_f32 v55, v30, v31
  s_waitcnt lgkmcnt(0)
  v_mfma_f32_32x32x16_bf16 v[16:31], v[92:95], v[88:91], v[72:87]
  ds_read_b128 v[96:99], v3 offset:5120
  v_exp_f32 v32, v32
  v_exp_f32 v33, v33
  v_exp_f32 v34, v34
  v_exp_f32 v35, v35
  v_exp_f32 v36, v36
  v_mfma_f32_32x32x16_bf16 v[56:71], v[104:107], v[52:55], v[56:71]
  ds_read_b128 v[100:103], v4 offset:4096
  v_exp_f32 v37, v37
  v_exp_f32 v38, v38
  v_exp_f32 v39, v39
  v_cvt_pk_bf16_f32 v48, v32, v33
  v_cvt_pk_bf16_f32 v49, v34, v35
  v_cvt_pk_bf16_f32 v50, v36, v37
  v_cvt_pk_bf16_f32 v51, v38, v39
  v_exp_f32 v40, v40
  v_exp_f32 v41, v41
  v_mfma_f32_32x32x16_bf16 v[56:71], v[108:111], v[48:51], v[56:71]
  ds_read_b128 v[112:115], v4 offset:3584
  v_exp_f32 v42, v42
  v_exp_f32 v43, v43
  v_exp_f32 v44, v44
  v_exp_f32 v45, v45
  v_exp_f32 v46, v46
  v_exp_f32 v47, v47
  v_cvt_pk_bf16_f32 v52, v40, v41
  v_cvt_pk_bf16_f32 v53, v42, v43
  v_cvt_pk_bf16_f32 v54, v44, v45
  v_cvt_pk_bf16_f32 v55, v46, v47
  s_waitcnt lgkmcnt(0)
  v_mfma_f32_32x32x16_bf16 v[32:47], v[96:99], v[88:91], v[72:87]
  ds_read_b128 v[92:95], v3 offset:6144
  v_exp_f32 v16, v16
  v_exp_f32 v17, v17
  v_exp_f32 v18, v18
  v_exp_f32 v19, v19
  v_exp_f32 v20, v20
  v_mfma_f32_32x32x16_bf16 v[56:71], v[112:115], v[52:55], v[56:71]
  ds_read_b128 v[108:111], v4 offset:5120
  v_exp_f32 v21, v21
  v_exp_f32 v22, v22
  v_exp_f32 v23, v23
  v_cvt_pk_bf16_f32 v48, v16, v17
  v_cvt_pk_bf16_f32 v49, v18, v19
  v_cvt_pk_bf16_f32 v50, v20, v21
  v_cvt_pk_bf16_f32 v51, v22, v23
  v_exp_f32 v24, v24
  v_exp_f32 v25, v25
  v_mfma_f32_32x32x16_bf16 v[56:71], v[100:103], v[48:51], v[56:71]
  ds_read_b128 v[104:107], v4 offset:4608
  v_exp_f32 v26, v26
  v_exp_f32 v27, v27
  v_exp_f32 v28, v28
  v_exp_f32 v29, v29
  v_exp_f32 v30, v30
  v_exp_f32 v31, v31
  v_cvt_pk_bf16_f32 v52, v24, v25
  v_cvt_pk_bf16_f32 v53, v26, v27
  v_cvt_pk_bf16_f32 v54, v28, v29
  v_cvt_pk_bf16_f32 v55, v30, v31
  s_waitcnt lgkmcnt(0)
  v_mfma_f32_32x32x16_bf16 v[16:31], v[92:95], v[88:91], v[72:87]
  ds_read_b128 v[96:99], v3 offset:7168
  v_exp_f32 v32, v32
  v_exp_f32 v33, v33
  v_exp_f32 v34, v34
  v_exp_f32 v35, v35
  v_exp_f32 v36, v36
  v_mfma_f32_32x32x16_bf16 v[56:71], v[104:107], v[52:55], v[56:71]
  ds_read_b128 v[100:103], v4 offset:6144
  v_exp_f32 v37, v37
  v_exp_f32 v38, v38
  v_exp_f32 v39, v39
  v_cvt_pk_bf16_f32 v48, v32, v33
  v_cvt_pk_bf16_f32 v49, v34, v35
  v_cvt_pk_bf16_f32 v50, v36, v37
  v_cvt_pk_bf16_f32 v51, v38, v39
  v_exp_f32 v40, v40
  v_exp_f32 v41, v41
  v_mfma_f32_32x32x16_bf16 v[56:71], v[108:111], v[48:51], v[56:71]
  ds_read_b128 v[112:115], v4 offset:5632
  v_exp_f32 v42, v42
  v_exp_f32 v43, v43
  v_exp_f32 v44, v44
  v_exp_f32 v45, v45
  v_exp_f32 v46, v46
  v_exp_f32 v47, v47
  v_cvt_pk_bf16_f32 v52, v40, v41
  v_cvt_pk_bf16_f32 v53, v42, v43
  v_cvt_pk_bf16_f32 v54, v44, v45
  v_cvt_pk_bf16_f32 v55, v46, v47
  s_waitcnt lgkmcnt(0)
  v_mfma_f32_32x32x16_bf16 v[32:47], v[96:99], v[88:91], v[72:87]
  ds_read_b128 v[92:95], v3 offset:8192
  v_exp_f32 v16, v16
  v_exp_f32 v17, v17
  v_exp_f32 v18, v18
  v_exp_f32 v19, v19
  v_exp_f32 v20, v20
  v_mfma_f32_32x32x16_bf16 v[56:71], v[112:115], v[52:55], v[56:71]
  ds_read_b128 v[108:111], v4 offset:7168
  v_exp_f32 v21, v21
  v_exp_f32 v22, v22
  v_exp_f32 v23, v23
  v_cvt_pk_bf16_f32 v48, v16, v17
  v_cvt_pk_bf16_f32 v49, v18, v19
  v_cvt_pk_bf16_f32 v50, v20, v21
  v_cvt_pk_bf16_f32 v51, v22, v23
  v_exp_f32 v24, v24
  v_exp_f32 v25, v25
  v_mfma_f32_32x32x16_bf16 v[56:71], v[100:103], v[48:51], v[56:71]
  ds_read_b128 v[104:107], v4 offset:6656
  v_exp_f32 v26, v26
  v_exp_f32 v27, v27
  v_exp_f32 v28, v28
  v_exp_f32 v29, v29
  v_exp_f32 v30, v30
  v_exp_f32 v31, v31
  v_cvt_pk_bf16_f32 v52, v24, v25
  v_cvt_pk_bf16_f32 v53, v26, v27
  v_cvt_pk_bf16_f32 v54, v28, v29
  v_cvt_pk_bf16_f32 v55, v30, v31
  s_waitcnt lgkmcnt(0)
  v_mfma_f32_32x32x16_bf16 v[16:31], v[92:95], v[88:91], v[72:87]
  ds_read_b128 v[96:99], v3 offset:9216
  v_exp_f32 v32, v32
  v_exp_f32 v33, v33
  v_exp_f32 v34, v34
  v_exp_f32 v35, v35
  v_exp_f32 v36, v36
  v_mfma_f32_32x32x16_bf16 v[56:71], v[104:107], v[52:55], v[56:71]
  ds_read_b128 v[100:103], v4 offset:8192
  v_exp_f32 v37, v37
  v_exp_f32 v38, v38
  v_exp_f32 v39, v39
  v_cvt_pk_bf16_f32 v48, v32, v33
  v_cvt_pk_bf16_f32 v49, v34, v35
  v_cvt_pk_bf16_f32 v50, v36, v37
  v_cvt_pk_bf16_f32 v51, v38, v39
  v_exp_f32 v40, v40
  v_exp_f32 v41, v41
  v_mfma_f32_32x32x16_bf16 v[56:71], v[108:111], v[48:51], v[56:71]
  ds_read_b128 v[112:115], v4 offset:7680
  v_exp_f32 v42, v42
  v_exp_f32 v43, v43
  v_exp_f32 v44, v44
  v_exp_f32 v45, v45
  v_exp_f32 v46, v46
  v_exp_f32 v47, v47
  v_add_u32 v3, 8192, v3
  v_add_u32 v4, v5, v4
  v_cvt_pk_bf16_f32 v52, v40, v41
  v_cvt_pk_bf16_f32 v53, v42, v43
  v_cvt_pk_bf16_f32 v54, v44, v45
  v_cvt_pk_bf16_f32 v55, v46, v47
  s_barrier
  s_mov_b32 s14, 6
.p2align 6
parallel_sum__mha_block__glu_gated_swiglu__prompt_kernel_yloop:
  s_waitcnt lgkmcnt(0)
  v_mfma_f32_32x32x16_bf16 v[32:47], v[96:99], v[88:91], v[72:87]
  ds_read_b128 v[92:95], v3 offset:2048
  v_exp_f32 v16, v16
  v_exp_f32 v17, v17
  v_exp_f32 v18, v18
  v_exp_f32 v19, v19
  v_exp_f32 v20, v20
  v_mfma_f32_32x32x16_bf16 v[56:71], v[112:115], v[52:55], v[56:71]
  ds_read_b128 v[108:111], v4 offset:1024
  v_exp_f32 v21, v21
  v_exp_f32 v22, v22
  v_exp_f32 v23, v23
  v_cvt_pk_bf16_f32 v48, v16, v17
  v_cvt_pk_bf16_f32 v49, v18, v19
  v_cvt_pk_bf16_f32 v50, v20, v21
  v_cvt_pk_bf16_f32 v51, v22, v23
  v_exp_f32 v24, v24
  v_exp_f32 v25, v25
  v_mfma_f32_32x32x16_bf16 v[56:71], v[100:103], v[48:51], v[56:71]
  ds_read_b128 v[104:107], v4 offset:512
  v_exp_f32 v26, v26
  v_exp_f32 v27, v27
  v_exp_f32 v28, v28
  v_exp_f32 v29, v29
  v_exp_f32 v30, v30
  v_exp_f32 v31, v31
  v_cvt_pk_bf16_f32 v52, v24, v25
  v_cvt_pk_bf16_f32 v53, v26, v27
  v_cvt_pk_bf16_f32 v54, v28, v29
  v_cvt_pk_bf16_f32 v55, v30, v31
  s_waitcnt lgkmcnt(0)
  v_mfma_f32_32x32x16_bf16 v[16:31], v[92:95], v[88:91], v[72:87]
  ds_read_b128 v[96:99], v3 offset:3072
  v_exp_f32 v32, v32
  v_exp_f32 v33, v33
  v_exp_f32 v34, v34
  v_exp_f32 v35, v35
  v_exp_f32 v36, v36
  v_mfma_f32_32x32x16_bf16 v[56:71], v[104:107], v[52:55], v[56:71]
  ds_read_b128 v[100:103], v4 offset:2048
  v_exp_f32 v37, v37
  v_exp_f32 v38, v38
  v_exp_f32 v39, v39
  v_cvt_pk_bf16_f32 v48, v32, v33
  v_cvt_pk_bf16_f32 v49, v34, v35
  v_cvt_pk_bf16_f32 v50, v36, v37
  v_cvt_pk_bf16_f32 v51, v38, v39
  v_exp_f32 v40, v40
  v_exp_f32 v41, v41
  v_mfma_f32_32x32x16_bf16 v[56:71], v[108:111], v[48:51], v[56:71]
  ds_read_b128 v[112:115], v4 offset:1536
  v_exp_f32 v42, v42
  v_exp_f32 v43, v43
  v_exp_f32 v44, v44
  v_exp_f32 v45, v45
  v_exp_f32 v46, v46
  v_exp_f32 v47, v47
  v_cvt_pk_bf16_f32 v52, v40, v41
  v_cvt_pk_bf16_f32 v53, v42, v43
  v_cvt_pk_bf16_f32 v54, v44, v45
  v_cvt_pk_bf16_f32 v55, v46, v47
  s_waitcnt lgkmcnt(0)
  v_mfma_f32_32x32x16_bf16 v[32:47], v[96:99], v[88:91], v[72:87]
  ds_read_b128 v[92:95], v3 offset:4096
  v_exp_f32 v16, v16
  v_exp_f32 v17, v17
  v_exp_f32 v18, v18
  v_exp_f32 v19, v19
  v_exp_f32 v20, v20
  v_mfma_f32_32x32x16_bf16 v[56:71], v[112:115], v[52:55], v[56:71]
  ds_read_b128 v[108:111], v4 offset:3072
  v_exp_f32 v21, v21
  v_exp_f32 v22, v22
  v_exp_f32 v23, v23
  v_cvt_pk_bf16_f32 v48, v16, v17
  v_cvt_pk_bf16_f32 v49, v18, v19
  v_cvt_pk_bf16_f32 v50, v20, v21
  v_cvt_pk_bf16_f32 v51, v22, v23
  v_exp_f32 v24, v24
  v_exp_f32 v25, v25
  v_mfma_f32_32x32x16_bf16 v[56:71], v[100:103], v[48:51], v[56:71]
  ds_read_b128 v[104:107], v4 offset:2560
  v_exp_f32 v26, v26
  v_exp_f32 v27, v27
  v_exp_f32 v28, v28
  v_exp_f32 v29, v29
  v_exp_f32 v30, v30
  v_exp_f32 v31, v31
  v_cvt_pk_bf16_f32 v52, v24, v25
  v_cvt_pk_bf16_f32 v53, v26, v27
  v_cvt_pk_bf16_f32 v54, v28, v29
  v_cvt_pk_bf16_f32 v55, v30, v31
  s_waitcnt lgkmcnt(0)
  v_mfma_f32_32x32x16_bf16 v[16:31], v[92:95], v[88:91], v[72:87]
  ds_read_b128 v[96:99], v3 offset:5120
  v_exp_f32 v32, v32
  v_exp_f32 v33, v33
  v_exp_f32 v34, v34
  v_exp_f32 v35, v35
  v_exp_f32 v36, v36
  v_mfma_f32_32x32x16_bf16 v[56:71], v[104:107], v[52:55], v[56:71]
  ds_read_b128 v[100:103], v4 offset:4096
  v_exp_f32 v37, v37
  v_exp_f32 v38, v38
  v_exp_f32 v39, v39
  v_cvt_pk_bf16_f32 v48, v32, v33
  v_cvt_pk_bf16_f32 v49, v34, v35
  v_cvt_pk_bf16_f32 v50, v36, v37
  v_cvt_pk_bf16_f32 v51, v38, v39
  v_exp_f32 v40, v40
  v_exp_f32 v41, v41
  v_mfma_f32_32x32x16_bf16 v[56:71], v[108:111], v[48:51], v[56:71]
  ds_read_b128 v[112:115], v4 offset:3584
  v_exp_f32 v42, v42
  v_exp_f32 v43, v43
  v_exp_f32 v44, v44
  v_exp_f32 v45, v45
  v_exp_f32 v46, v46
  v_exp_f32 v47, v47
  v_cvt_pk_bf16_f32 v52, v40, v41
  v_cvt_pk_bf16_f32 v53, v42, v43
  v_cvt_pk_bf16_f32 v54, v44, v45
  v_cvt_pk_bf16_f32 v55, v46, v47
  s_waitcnt lgkmcnt(0)
  v_mfma_f32_32x32x16_bf16 v[32:47], v[96:99], v[88:91], v[72:87]
  ds_read_b128 v[92:95], v3 offset:6144
  v_exp_f32 v16, v16
  v_exp_f32 v17, v17
  v_exp_f32 v18, v18
  v_exp_f32 v19, v19
  v_exp_f32 v20, v20
  v_mfma_f32_32x32x16_bf16 v[56:71], v[112:115], v[52:55], v[56:71]
  ds_read_b128 v[108:111], v4 offset:5120
  v_exp_f32 v21, v21
  v_exp_f32 v22, v22
  v_exp_f32 v23, v23
  v_cvt_pk_bf16_f32 v48, v16, v17
  v_cvt_pk_bf16_f32 v49, v18, v19
  v_cvt_pk_bf16_f32 v50, v20, v21
  v_cvt_pk_bf16_f32 v51, v22, v23
  v_exp_f32 v24, v24
  v_exp_f32 v25, v25
  v_mfma_f32_32x32x16_bf16 v[56:71], v[100:103], v[48:51], v[56:71]
  ds_read_b128 v[104:107], v4 offset:4608
  v_exp_f32 v26, v26
  v_exp_f32 v27, v27
  v_exp_f32 v28, v28
  v_exp_f32 v29, v29
  v_exp_f32 v30, v30
  v_exp_f32 v31, v31
  v_cvt_pk_bf16_f32 v52, v24, v25
  v_cvt_pk_bf16_f32 v53, v26, v27
  v_cvt_pk_bf16_f32 v54, v28, v29
  v_cvt_pk_bf16_f32 v55, v30, v31
  s_waitcnt lgkmcnt(0)
  v_mfma_f32_32x32x16_bf16 v[16:31], v[92:95], v[88:91], v[72:87]
  ds_read_b128 v[96:99], v3 offset:7168
  v_exp_f32 v32, v32
  v_exp_f32 v33, v33
  v_exp_f32 v34, v34
  v_exp_f32 v35, v35
  v_exp_f32 v36, v36
  v_mfma_f32_32x32x16_bf16 v[56:71], v[104:107], v[52:55], v[56:71]
  ds_read_b128 v[100:103], v4 offset:6144
  v_exp_f32 v37, v37
  v_exp_f32 v38, v38
  v_exp_f32 v39, v39
  v_cvt_pk_bf16_f32 v48, v32, v33
  v_cvt_pk_bf16_f32 v49, v34, v35
  v_cvt_pk_bf16_f32 v50, v36, v37
  v_cvt_pk_bf16_f32 v51, v38, v39
  v_exp_f32 v40, v40
  v_exp_f32 v41, v41
  v_mfma_f32_32x32x16_bf16 v[56:71], v[108:111], v[48:51], v[56:71]
  ds_read_b128 v[112:115], v4 offset:5632
  v_exp_f32 v42, v42
  v_exp_f32 v43, v43
  v_exp_f32 v44, v44
  v_exp_f32 v45, v45
  v_exp_f32 v46, v46
  v_exp_f32 v47, v47
  v_cvt_pk_bf16_f32 v52, v40, v41
  v_cvt_pk_bf16_f32 v53, v42, v43
  v_cvt_pk_bf16_f32 v54, v44, v45
  v_cvt_pk_bf16_f32 v55, v46, v47
  s_waitcnt lgkmcnt(0)
  v_mfma_f32_32x32x16_bf16 v[32:47], v[96:99], v[88:91], v[72:87]
  ds_read_b128 v[92:95], v3 offset:8192
  v_exp_f32 v16, v16
  v_exp_f32 v17, v17
  v_exp_f32 v18, v18
  v_exp_f32 v19, v19
  v_exp_f32 v20, v20
  v_mfma_f32_32x32x16_bf16 v[56:71], v[112:115], v[52:55], v[56:71]
  ds_read_b128 v[108:111], v4 offset:7168
  v_exp_f32 v21, v21
  v_exp_f32 v22, v22
  v_exp_f32 v23, v23
  v_cvt_pk_bf16_f32 v48, v16, v17
  v_cvt_pk_bf16_f32 v49, v18, v19
  v_cvt_pk_bf16_f32 v50, v20, v21
  v_cvt_pk_bf16_f32 v51, v22, v23
  v_exp_f32 v24, v24
  v_exp_f32 v25, v25
  v_mfma_f32_32x32x16_bf16 v[56:71], v[100:103], v[48:51], v[56:71]
  ds_read_b128 v[104:107], v4 offset:6656
  v_exp_f32 v26, v26
  v_exp_f32 v27, v27
  v_exp_f32 v28, v28
  v_exp_f32 v29, v29
  v_exp_f32 v30, v30
  v_exp_f32 v31, v31
  v_cvt_pk_bf16_f32 v52, v24, v25
  v_cvt_pk_bf16_f32 v53, v26, v27
  v_cvt_pk_bf16_f32 v54, v28, v29
  v_cvt_pk_bf16_f32 v55, v30, v31
  s_waitcnt lgkmcnt(0)
  v_mfma_f32_32x32x16_bf16 v[16:31], v[92:95], v[88:91], v[72:87]
  ds_read_b128 v[96:99], v3 offset:9216
  v_exp_f32 v32, v32
  v_exp_f32 v33, v33
  v_exp_f32 v34, v34
  v_exp_f32 v35, v35
  v_exp_f32 v36, v36
  v_mfma_f32_32x32x16_bf16 v[56:71], v[104:107], v[52:55], v[56:71]
  ds_read_b128 v[100:103], v4 offset:8192
  v_exp_f32 v37, v37
  v_exp_f32 v38, v38
  v_exp_f32 v39, v39
  v_cvt_pk_bf16_f32 v48, v32, v33
  v_cvt_pk_bf16_f32 v49, v34, v35
  v_cvt_pk_bf16_f32 v50, v36, v37
  v_cvt_pk_bf16_f32 v51, v38, v39
  v_exp_f32 v40, v40
  v_exp_f32 v41, v41
  v_mfma_f32_32x32x16_bf16 v[56:71], v[108:111], v[48:51], v[56:71]
  ds_read_b128 v[112:115], v4 offset:7680
  v_exp_f32 v42, v42
  v_exp_f32 v43, v43
  v_exp_f32 v44, v44
  v_exp_f32 v45, v45
  v_exp_f32 v46, v46
  v_exp_f32 v47, v47
  v_add_u32 v3, 8192, v3
  v_add_u32 v4, v5, v4
  v_cvt_pk_bf16_f32 v52, v40, v41
  v_cvt_pk_bf16_f32 v53, v42, v43
  v_cvt_pk_bf16_f32 v54, v44, v45
  v_cvt_pk_bf16_f32 v55, v46, v47
  s_sub_u32 s14, s14, 1
  s_cmp_lg_u32 s14, 0
  s_cbranch_scc1 parallel_sum__mha_block__glu_gated_swiglu__prompt_kernel_yloop
  s_setprio 0
  s_waitcnt lgkmcnt(0)
  v_mfma_f32_32x32x16_bf16 v[56:71], v[112:115], v[52:55], v[56:71]
  s_lshl_b32 s15, s10, 15
  s_lshl_b32 s16, s8, 10
  s_add_u32 s15, s15, s16
  s_add_u32 s15, s15, 12582912
  s_nop 15
  v_rcp_f32 v10, v64
  s_nop 0
  v_mul_f32 v56, v10, v56
  v_mul_f32 v57, v10, v57
  v_mul_f32 v58, v10, v58
  v_mul_f32 v59, v10, v59
  v_mul_f32 v60, v10, v60
  v_mul_f32 v61, v10, v61
  v_mul_f32 v62, v10, v62
  v_mul_f32 v63, v10, v63
  v_cvt_pk_bf16_f32 v48, v56, v57
  v_cvt_pk_bf16_f32 v49, v58, v59
  v_cvt_pk_bf16_f32 v50, v60, v61
  v_cvt_pk_bf16_f32 v51, v62, v63
  buffer_store_dwordx4 v[48:51], v2, s[20:23], s15 offen sc1
  v_mov_b32 v116, 0
  v_mov_b32 v117, 0
  v_mov_b32 v118, 0
  v_mov_b32 v119, 0
  v_mov_b32 v120, 0
  v_mov_b32 v121, 0
  v_mov_b32 v122, 0
  v_mov_b32 v123, 0
  v_mov_b32 v124, 0
  v_mov_b32 v125, 0
  v_mov_b32 v126, 0
  v_mov_b32 v127, 0
  v_mov_b32 v128, 0
  v_mov_b32 v129, 0
  v_mov_b32 v130, 0
  v_mov_b32 v131, 0
parallel_sum__mha_block__glu_gated_swiglu__prompt_kernel_ph3:
  s_barrier
  s_cmp_ge_u32 s34, 4
  s_cbranch_scc0 parallel_sum__mha_block__glu_gated_swiglu__prompt_kernel_yw_21
  s_add_u32 s15, s33, 16384
  buffer_load_dwordx4 v[132:135], v2, s[20:23], s15 offen sc1
  s_add_u32 s15, s33, 17408
  buffer_load_dwordx4 v[136:139], v2, s[20:23], s15 offen sc1
  s_add_u32 s15, s33, 18432
  buffer_load_dwordx4 v[140:143], v2, s[20:23], s15 offen sc1
  s_add_u32 s15, s33, 19456
  buffer_load_dwordx4 v[144:147], v2, s[20:23], s15 offen sc1
  s_add_u32 s15, s33, 20480
  buffer_load_dwordx4 v[148:151], v2, s[20:23], s15 offen sc1
  s_add_u32 s15, s33, 21504
  buffer_load_dwordx4 v[152:155], v2, s[20:23], s15 offen sc1
  s_add_u32 s15, s33, 22528
  buffer_load_dwordx4 v[156:159], v2, s[20:23], s15 offen sc1
  s_add_u32 s15, s33, 23552
  buffer_load_dwordx4 v[160:163], v2, s[20:23], s15 offen sc1
  s_add_u32 s15, s33, 24576
  buffer_load_dwordx4 v[164:167], v2, s[20:23], s15 offen sc1
  s_add_u32 s15, s33, 25600
  buffer_load_dwordx4 v[168:171], v2, s[20:23], s15 offen sc1
  s_add_u32 s15, s33, 26624
  buffer_load_dwordx4 v[172:175], v2, s[20:23], s15 offen sc1
  s_add_u32 s15, s33, 27648
  buffer_load_dwordx4 v[176:179], v2, s[20:23], s15 offen sc1
  s_add_u32 s15, s33, 28672
  buffer_load_dwordx4 v[180:183], v2, s[20:23], s15 offen sc1
  s_add_u32 s15, s33, 29696
  buffer_load_dwordx4 v[184:187], v2, s[20:23], s15 offen sc1
  s_add_u32 s15, s33, 30720
  buffer_load_dwordx4 v[188:191], v2, s[20:23], s15 offen sc1
  s_add_u32 s15, s33, 31744
  buffer_load_dwordx4 v[192:195], v2, s[20:23], s15 offen sc1
parallel_sum__mha_block__glu_gated_swiglu__prompt_kernel_yw_21:
  s_mov_b32 s24, s70
  s_mov_b32 s25, s71
  s_mov_b32 s26, 2097152
  s_mov_b32 s27, 0x20000
  s_mov_b32 s28, s72
  s_mov_b32 s29, s73
  s_mov_b32 s30, 2097152
  s_mov_b32 s31, 0x20000
  v_lshrrev_b32 v4, 4, v0
  v_and_b32 v5, 15, v0
  v_lshlrev_b32 v6, 10, v4
  v_lshlrev_b32 v7, 4, v5
  v_add_u32 v6, v6, v7
  s_lshl_b32 s15, s60, 15
  s_lshl_b32 s16, s61, 8
  s_add_u32 s37, s15, s16
  v_and_b32 v12, 31, v0
  v_lshlrev_b32 v12, 2, v12
  s_lshr_b32 s15, s60, 3
  s_lshl_b32 s15, s15, 7
  s_add_u32 s15, s15, 24649728
  v_add_u32 v12, s15, v12
  s_lshr_b32 s17, s34, 2
  s_lshl_b32 s18, s17, 14
  v_add_u32 v8, s18, v2
  v_and_b32 v9, 63, v0
  v_and_b32 v10, 31, v9
  v_lshrrev_b32 v11, 5, v9
  v_mul_u32_u24 v10, 528, v10
  s_and_b32 s16, s34, 3
  s_lshl_b32 s16, s16, 7
  v_lshlrev_b32 v11, 4, v11
  v_add_u32 v10, v10, v11
  s_mul_i32 s17, s17, 16896
  s_add_u32 s16, s16, s17
  s_add_u32 s16, s16, 65536
  v_add_u32 v10, s16, v10
  v_mul_u32_u24 v11, 528, v4
  v_lshlrev_b32 v13, 5, v5
  v_add_u32 v11, v11, v13
  v_add_u32 v11, 65536, v11
  s_lshl_b32 s16, s34, 12
  s_lshl_b32 s15, s60, 15
  s_add_u32 s15, s15, 12582912
  s_add_u32 s17, s15, s16
  buffer_load_dwordx4 v[36:39], v6, s[24:27], s37 offen
  v_add_u32 v12, s16, v2
  s_mov_b32 m0, s16
  s_mov_b32 s77, 20000
parallel_sum__mha_block__glu_gated_swiglu__prompt_kernel_sl_22:
  buffer_load_dwordx4 v2, s[20:23], s17 offen offset:0 sc1 lds
  buffer_load_dwordx4 v2, s[20:23], s17 offen offset:1024 sc1 lds
  buffer_load_dwordx4 v2, s[20:23], s17 offen offset:2048 sc1 lds
  buffer_load_dwordx4 v2, s[20:23], s17 offen offset:3072 sc1 lds
  s_waitcnt vmcnt(0)
  ds_read_b128 v[40:43], v12 offset:0
  ds_read_b128 v[44:47], v12 offset:1024
  ds_read_b128 v[48:51], v12 offset:2048
  ds_read_b128 v[52:55], v12 offset:3072
  v_mov_b32 v13, 0
  s_waitcnt lgkmcnt(3)
  v_max3_u32 v13, v40, v41, v13
  v_max3_u32 v13, v42, v43, v13
  s_waitcnt lgkmcnt(2)
  v_max3_u32 v13, v44, v45, v13
  v_max3_u32 v13, v46, v47, v13
  s_waitcnt lgkmcnt(1)
  v_max3_u32 v13, v48, v49, v13
  v_max3_u32 v13, v50, v51, v13
  s_waitcnt lgkmcnt(0)
  v_max3_u32 v13, v52, v53, v13
  v_max3_u32 v13, v54, v55, v13
  v_cmp_eq_u32 vcc, -1, v13
  s_cmp_eq_u64 vcc, 0
  s_cbranch_scc1 parallel_sum__mha_block__glu_gated_swiglu__prompt_kernel_sl_22_ok
  s_sub_u32 s77, s77, 1
  s_cmp_lg_u32 s77, 0
  s_cbranch_scc1 parallel_sum__mha_block__glu_gated_swiglu__prompt_kernel_sl_22
parallel_sum__mha_block__glu_gated_swiglu__prompt_kernel_sl_22_ok:
  s_barrier
  ds_read_b128 v[20:23], v8 offset:0
  ds_read_b128 v[24:27], v8 offset:1024
  ds_read_b128 v[28:31], v8 offset:2048
  ds_read_b128 v[32:35], v8 offset:3072
  s_waitcnt lgkmcnt(3)
  v_mfma_f32_32x32x16_bf16 v[116:131], v[132:135], v[20:23], v[116:131]
  ds_read_b128 v[20:23], v8 offset:4096
  s_waitcnt lgkmcnt(3)
  v_mfma_f32_32x32x16_bf16 v[116:131], v[136:139], v[24:27], v[116:131]
  ds_read_b128 v[24:27], v8 offset:5120
  s_waitcnt lgkmcnt(3)
  v_mfma_f32_32x32x16_bf16 v[116:131], v[140:143], v[28:31], v[116:131]
  ds_read_b128 v[28:31], v8 offset:6144
  s_waitcnt lgkmcnt(3)
  v_mfma_f32_32x32x16_bf16 v[116:131], v[144:147], v[32:35], v[116:131]
  ds_read_b128 v[32:35], v8 offset:7168
  s_waitcnt lgkmcnt(3)
  v_mfma_f32_32x32x16_bf16 v[116:131], v[148:151], v[20:23], v[116:131]
  ds_read_b128 v[20:23], v8 offset:8192
  s_waitcnt lgkmcnt(3)
  v_mfma_f32_32x32x16_bf16 v[116:131], v[152:155], v[24:27], v[116:131]
  ds_read_b128 v[24:27], v8 offset:9216
  s_waitcnt lgkmcnt(3)
  v_mfma_f32_32x32x16_bf16 v[116:131], v[156:159], v[28:31], v[116:131]
  ds_read_b128 v[28:31], v8 offset:10240
  s_waitcnt lgkmcnt(3)
  v_mfma_f32_32x32x16_bf16 v[116:131], v[160:163], v[32:35], v[116:131]
  ds_read_b128 v[32:35], v8 offset:11264
  s_waitcnt lgkmcnt(3)
  v_mfma_f32_32x32x16_bf16 v[116:131], v[164:167], v[20:23], v[116:131]
  ds_read_b128 v[20:23], v8 offset:12288
  s_waitcnt lgkmcnt(3)
  v_mfma_f32_32x32x16_bf16 v[116:131], v[168:171], v[24:27], v[116:131]
  ds_read_b128 v[24:27], v8 offset:13312
  s_waitcnt lgkmcnt(3)
  v_mfma_f32_32x32x16_bf16 v[116:131], v[172:175], v[28:31], v[116:131]
  ds_read_b128 v[28:31], v8 offset:14336
  s_waitcnt lgkmcnt(3)
  v_mfma_f32_32x32x16_bf16 v[116:131], v[176:179], v[32:35], v[116:131]
  ds_read_b128 v[32:35], v8 offset:15360
  s_waitcnt lgkmcnt(3)
  v_mfma_f32_32x32x16_bf16 v[116:131], v[180:183], v[20:23], v[116:131]
  s_waitcnt lgkmcnt(2)
  v_mfma_f32_32x32x16_bf16 v[116:131], v[184:187], v[24:27], v[116:131]
  s_waitcnt lgkmcnt(1)
  v_mfma_f32_32x32x16_bf16 v[116:131], v[188:191], v[28:31], v[116:131]
  s_waitcnt lgkmcnt(0)
  v_mfma_f32_32x32x16_bf16 v[116:131], v[192:195], v[32:35], v[116:131]
  s_nop 15
  s_nop 3
  ds_write_b128 v10, v[116:119] offset:0
  ds_write_b128 v10, v[120:123] offset:32
  ds_write_b128 v10, v[124:127] offset:64
  ds_write_b128 v10, v[128:131] offset:96
  s_waitcnt lgkmcnt(0)
parallel_sum__mha_block__glu_gated_swiglu__prompt_kernel_j3_24:
  s_barrier
  ds_read_b128 v[40:43], v11
  ds_read_b128 v[44:47], v11 offset:16
  ds_read_b128 v[48:51], v11 offset:16896
  ds_read_b128 v[52:55], v11 offset:16912
  s_waitcnt vmcnt(0) lgkmcnt(0)
  v_add_f32 v40, v40, v48
  v_add_f32 v41, v41, v49
  v_add_f32 v42, v42, v50
  v_add_f32 v43, v43, v51
  v_add_f32 v44, v44, v52
  v_add_f32 v45, v45, v53
  v_add_f32 v46, v46, v54
  v_add_f32 v47, v47, v55
  s_mov_b32 s15, 0xffff0000
  v_lshlrev_b32 v13, 16, v36
  v_and_b32 v14, s15, v36
  v_add_f32 v40, v40, v13
  v_add_f32 v41, v41, v14
  v_lshlrev_b32 v13, 16, v37
  v_and_b32 v14, s15, v37
  v_add_f32 v42, v42, v13
  v_add_f32 v43, v43, v14
  v_lshlrev_b32 v13, 16, v38
  v_and_b32 v14, s15, v38
  v_add_f32 v44, v44, v13
  v_add_f32 v45, v45, v14
  v_lshlrev_b32 v13, 16, v39
  v_and_b32 v14, s15, v39
  v_add_f32 v46, v46, v13
  v_add_f32 v47, v47, v14
  v_cvt_pk_bf16_f32 v36, v40, v41
  v_cvt_pk_bf16_f32 v37, v42, v43
  v_cvt_pk_bf16_f32 v38, v44, v45
  v_cvt_pk_bf16_f32 v39, v46, v47
  buffer_store_dwordx4 v[36:39], v6, s[28:31], s37 offen sc1
  s_waitcnt vmcnt(0)
parallel_sum__mha_block__glu_gated_swiglu__prompt_kernel_exit:
  s_endpgm

.section .rodata,"a"
.p2align 6
.amdhsa_kernel parallel_sum__mha_block__glu_gated_swiglu__prompt_kernel
  .amdhsa_next_free_vgpr 256
  .amdhsa_next_free_sgpr 102
  .amdhsa_accum_offset 256
  .amdhsa_group_segment_fixed_size 0
  .amdhsa_kernarg_size 80
  .amdhsa_user_sgpr_count 2
  .amdhsa_user_sgpr_kernarg_segment_ptr 1
  .amdhsa_system_sgpr_workgroup_id_x 1
  .amdhsa_float_denorm_mode_32 3
.end_amdhsa_kernel
```
